```python
import torch

def _softmax(x, axis=-1):
    return torch.softmax(x, dim=axis)
def _gelu(x):
    return torch.nn.functional.gelu(x, approximate="tanh")
def _silu(x):
    return torch.nn.functional.silu(x)
def _sigmoid(x):
    return torch.sigmoid(x)
def _layernorm(x, axis=-1, eps=1e-5):
    m = x.mean(dim=axis, keepdim=True)
    v = x.var(dim=axis, keepdim=True, unbiased=False)
    return (x - m) / torch.sqrt(v + eps)
def _scatter_add(tgt, idx, src, axis=0):
    return tgt.clone().index_add_(axis, idx, src)
def _segment_sum(src, seg, n):
    out = torch.zeros((n,) + src.shape[1:], dtype=src.dtype)
    return out.index_add_(0, seg, src)
def _pad(x, pw):
    flat = tuple(v for pair in reversed(pw) for v in pair)
    return torch.nn.functional.pad(x, flat)

kernel_name = 'sequential_preLN__sliding_block_cached__glu_gated_swiglu__decode'

def setup_inputs():

    _w = (lambda a: (lambda t: t.to(torch.bfloat16) if t.is_floating_point() else t)(torch.as_tensor(a)))
    def _A_setup():
        B, Sq, D = 2, 1, 576
        Hq, Hkv, Sk, Dh = 32, 16, 8192, 128
        assert Hq % Hkv == 0, (Hq, Hkv)
        return {
            "x": _w((lambda *s: torch.randn(*s, dtype=torch.bfloat16) * 0.05)(B, Sq, D)),
            "k_cache": _w((lambda *s: torch.randn(*s, dtype=torch.bfloat16) * 1.6)(B, Hkv, Sk, Dh)),
            "v_cache": _w((lambda *s: torch.randn(*s, dtype=torch.bfloat16) * 0.8)(B, Hkv, Sk, Dh)),
            "wq": _w((lambda *s: torch.randn(*s, dtype=torch.bfloat16) * 1.6)(D, Hq * Dh) * (D ** -0.5)),
            "wo": _w((lambda *s: torch.randn(*s, dtype=torch.bfloat16) * 0.8)(Hq * Dh, D) * ((Hq * Dh) ** -0.5)),
        }
    _A_in = _A_setup()

    def _B_setup():
        B, S, D, F = 2, 1, 576, 4608
        return {
            "x": _w((lambda *s: torch.randn(*s, dtype=torch.bfloat16) * 0.05)(B, S, D)),
            "w1": _w((lambda *s: torch.randn(*s, dtype=torch.bfloat16) * 0.4)(D, F) * (2.0 / D) ** 0.5),
            "w3": _w((lambda *s: torch.randn(*s, dtype=torch.bfloat16) * 0.4)(D, F) * (2.0 / D) ** 0.5),
            "w2": _w((lambda *s: torch.randn(*s, dtype=torch.bfloat16) * 0.4)(F, D) * (2.0 / F) ** 0.5),
        }
    _B_in = _B_setup()

    return {
        "A_x": _A_in["x"],
        "A_k_cache": _A_in["k_cache"],
        "A_v_cache": _A_in["v_cache"],
        "A_wq": _A_in["wq"],
        "A_wo": _A_in["wo"],
        "B_x": _B_in["x"],
        "B_w1": _B_in["w1"],
        "B_w3": _B_in["w3"],
        "B_w2": _B_in["w2"],
    }

def reference(A_x, A_k_cache, A_v_cache, A_wq, A_wo, B_x, B_w1, B_w3, B_w2):
    def _A_ref(x, k_cache, v_cache, wq, wo):
        B, Sq, D = x.shape
        Hq, Dh = 32, 128
        Hkv, Sk = k_cache.shape[1], k_cache.shape[2]
        W = min(4096, max(256, Sk // 4))
        rep = Hq // Hkv
        q = (lambda x, *d: x.permute(*d))((x @ wq).reshape(B, Sq, Hq, Dh), 0, 2, 1, 3)
        k = (lambda x, n, axis: torch.repeat_interleave(x, n, dim=axis))(k_cache[:, :, Sk - W:, :], rep, axis=1)
        v = (lambda x, n, axis: torch.repeat_interleave(x, n, dim=axis))(v_cache[:, :, Sk - W:, :], rep, axis=1)
        scores = torch.einsum("bhqd,bhkd->bhqk", q, k) * (Dh ** -0.5)
        p = _softmax(scores, axis=-1)
        o = torch.einsum("bhqk,bhkd->bhqd", p, v)
        return (lambda x, *d: x.permute(*d))(o, 0, 2, 1, 3).reshape(B, Sq, Hq * Dh) @ wo

    def _B_ref(x, w1, w3, w2):
        gate = torch.einsum("bsd,df->bsf", x, w1)
        up = torch.einsum("bsd,df->bsf", x, w3)
        h = _silu(gate) * up
        out = torch.einsum("bsf,fd->bsd", h, w2)
        return out

    x = A_x
    h = x + _A_ref(_layernorm(x, axis=-1), A_k_cache, A_v_cache, A_wq, A_wo)
    h2 = h + _B_ref(_layernorm(h, axis=-1), B_w1, B_w3, B_w2)
    return h2
```

```asm
; @launch grid=(256,1,1) block=(256,1,1) lds=100000
.amdgcn_target "amdgcn-amd-amdhsa--gfx950"
.text
.globl sequential_preLN__sliding_block_cached__glu_gated_swiglu__decode_kernel
.p2align 8
.type sequential_preLN__sliding_block_cached__glu_gated_swiglu__decode_kernel,@function
sequential_preLN__sliding_block_cached__glu_gated_swiglu__decode_kernel:
    s_cmp_ge_u32 s2, 256
    s_cbranch_scc1 L_end
    s_load_dwordx16 s[16:31], s[0:1], 0
    s_load_dwordx8 s[32:39], s[0:1], 64
    v_lshrrev_b32 v1, 6, v0
    v_and_b32 v0, 63, v0
    v_readfirstlane_b32 s3, v1
    s_getpc_b64 s[98:99]
    v_lshlrev_b32 v3, 7, v0
    s_lshl_b32 s8, s3, 13
    s_add_u32 s98, s98, s8
    s_addc_u32 s99, s99, 0
    v_add_u32 v4, s8, v3
    v_cmp_gt_u32 vcc, (L_end - sequential_preLN__sliding_block_cached__glu_gated_swiglu__decode_kernel - 64), v4
    s_and_saveexec_b64 s[100:101], vcc
    s_cbranch_execz L_nopf
    global_load_dword v255, v3, s[98:99]
L_nopf:
    s_mov_b64 exec, -1
    s_and_b32 s4, s2, 7
    s_lshr_b32 s5, s2, 3
    s_lshr_b32 s6, s5, 4
    s_lshl_b32 s7, s4, 1
    s_add_u32 s6, s6, s7
    s_and_b32 s7, s5, 15
    s_lshl_b32 s99, s4, 18
    s_mul_i32 s98, s4, 229376
    v_and_b32 v1, 15, v0
    v_lshrrev_b32 v2, 4, v0
    v_lshrrev_b32 v4, 5, v0
    v_and_b32 v5, 31, v0
    v_mul_u32_u24 v6, 36, v5
    v_mul_u32_u24 v7, 1152, v4
    v_add_u32 v6, v6, v7
    v_lshl_add_u32 v7, v5, 1, v7
    v_mul_u32_u24 v8, 8192, v2
    v_lshl_add_u32 v8, v1, 4, v8
    s_mov_b32 s77, 0x3ff
    s_mov_b32 s79, 0
    s_waitcnt lgkmcnt(0)
    s_load_dword s78, s[38:39], 0
    s_mov_b32 s68, s16
    s_and_b32 s69, s17, 0xffff
    s_mov_b32 s70, 2304
    s_mov_b32 s71, 0x00020000
    s_mov_b32 s48, s22
    s_and_b32 s49, s23, 0xffff
    s_mov_b32 s50, 4718592
    s_mov_b32 s51, 0x00020000
    s_mov_b32 s64, s38
    s_and_b32 s65, s39, 0xffff
    s_mov_b32 s66, 268435456
    s_mov_b32 s67, 0x00020000
    buffer_load_dwordx4 v[60:63], v6, s[68:71], 0 offen
    buffer_load_dwordx4 v[64:67], v6, s[68:71], 0 offen offset:16
    buffer_load_dword v68, v6, s[68:71], 0 offen offset:32
    s_lshr_b32 s9, s7, 1
    s_mul_i32 s10, s9, 144
    buffer_load_ushort v69, v7, s[68:71], s10 offen offset:0
    buffer_load_ushort v70, v7, s[68:71], s10 offen offset:64
    buffer_load_ushort v71, v7, s[68:71], s10 offen offset:128
    s_and_b32 s8, s7, 1
    s_lshl_b32 s11, s6, 1
    s_add_u32 s11, s8, s11
    s_lshl_b32 s8, s11, 8
    s_mul_i32 s12, s9, 72
    s_lshl_b32 s10, s3, 2
    s_add_u32 s12, s12, s10
    s_lshl_b32 s12, s12, 13
    s_add_u32 s8, s8, s12
    buffer_load_dwordx4 v[40:43], v8, s[48:51], s8 offen nt
    s_add_u32 s8, s8, 131072
    buffer_load_dwordx4 v[44:47], v8, s[48:51], s8 offen nt
    s_add_u32 s8, s8, 131072
    buffer_load_dwordx4 v[48:51], v8, s[48:51], s8 offen nt
    s_add_u32 s8, s8, 131072
    buffer_load_dwordx4 v[52:55], v8, s[48:51], s8 offen nt
    s_add_u32 s8, s8, 131072
    s_cmp_ge_u32 s3, 2
    s_cselect_b32 s8, 0x7fffffff, s8
    buffer_load_dwordx4 v[56:59], v8, s[48:51], s8 offen nt
    s_lshl_b32 s13, s11, 3
    s_add_u32 s13, s13, s9
    s_lshl_b32 s13, s13, 10
    s_add_u32 s13, s13, 262144
    s_add_u32 s13, s13, s98
    s_mov_b32 s40, s18
    s_and_b32 s41, s19, 0xffff
    s_mov_b32 s42, 67108864
    s_mov_b32 s43, 0x00020000
    s_mov_b32 s44, s20
    s_and_b32 s45, s21, 0xffff
    s_mov_b32 s46, 67108864
    s_mov_b32 s47, 0x00020000
    s_lshr_b32 s8, s7, 3
    s_lshl_b32 s14, s8, 25
    s_lshl_b32 s9, s6, 21
    s_add_u32 s14, s14, s9
    s_and_b32 s9, s7, 7
    s_lshl_b32 s9, s9, 14
    s_add_u32 s14, s14, s9
    s_lshl_b32 s9, s3, 12
    s_add_u32 s14, s14, s9
    s_add_u32 s14, s14, 1572864
    s_mov_b32 s15, s14
    v_add_u32 v10, 0, v2
    v_xor_b32 v10, v10, v1
    v_lshlrev_b32 v10, 4, v10
    v_lshl_add_u32 v10, v2, 8, v10
    v_add_u32 v11, 4, v2
    v_xor_b32 v11, v11, v1
    v_lshlrev_b32 v11, 4, v11
    v_lshl_add_u32 v11, v2, 8, v11
    v_add_u32 v12, 8, v2
    v_xor_b32 v12, v12, v1
    v_lshlrev_b32 v12, 4, v12
    v_lshl_add_u32 v12, v2, 8, v12
    v_add_u32 v13, 12, v2
    v_xor_b32 v13, v13, v1
    v_lshlrev_b32 v13, 4, v13
    v_lshl_add_u32 v13, v2, 8, v13
    s_lshl_b32 s100, s3, 14
    s_add_u32 s101, s100, 0
    s_mov_b32 m0, s101
    s_nop 0
    buffer_load_dwordx4 v10, s[40:43], s14 offen offset:0 nt lds
    buffer_load_dwordx4 v11, s[40:43], s14 offen offset:1024 nt lds
    buffer_load_dwordx4 v12, s[40:43], s14 offen offset:2048 nt lds
    buffer_load_dwordx4 v13, s[40:43], s14 offen offset:3072 nt lds
    s_add_u32 s14, s14, 131072
    s_add_u32 s101, s100, 4096
    s_mov_b32 m0, s101
    s_nop 0
    buffer_load_dwordx4 v10, s[40:43], s14 offen offset:0 nt lds
    buffer_load_dwordx4 v11, s[40:43], s14 offen offset:1024 nt lds
    s_sub_u32 s74, s5, 18
    s_mov_b32 s52, s24
    s_and_b32 s53, s25, 0xffff
    s_mov_b32 s54, 4718592
    s_mov_b32 s55, 0x00020000
    v_lshrrev_b32 v236, 3, v1
    v_lshlrev_b32 v236, 3, v236
    v_lshl_add_u32 v236, v2, 1, v236
    v_mul_u32_u24 v236, 1152, v236
    v_and_b32 v14, 7, v1
    v_lshl_add_u32 v236, v14, 4, v236
    s_and_b32 s8, s74, 15
    s_mul_i32 s73, s8, 11
    s_lshr_b32 s73, s73, 5
    s_mul_i32 s9, s73, 3
    s_sub_u32 s80, s8, s9
    s_lshl_b32 s8, s4, 2
    s_add_u32 s73, s73, s8
    s_lshl_b32 s8, s73, 7
    s_lshl_b32 s9, s3, 5
    s_add_u32 s8, s8, s9
    s_mul_i32 s8, s8, 1152
    s_mul_i32 s9, s80, 384
    s_add_u32 s81, s8, s9
    s_cmp_ge_u32 s74, 12
    s_cselect_b32 s81, 0x7fff0000, s81
    s_add_u32 s82, s81, 18432
    v_and_b32 v14, 1, v1
    v_cmp_eq_u32 vcc, 1, v14
    v_mov_b32 v15, 0xffff
    v_mov_b32 v16, 0xffff0000
    v_cndmask_b32 v14, v15, v16, vcc
    v_bfe_u32 v15, v1, 1, 2
    v_cmp_eq_u32 vcc, 0, v15
    s_nop 1
    v_cndmask_b32 v32, 0, v14, vcc
    v_cmp_eq_u32 vcc, 1, v15
    s_nop 1
    v_cndmask_b32 v33, 0, v14, vcc
    v_cmp_eq_u32 vcc, 2, v15
    s_nop 1
    v_cndmask_b32 v34, 0, v14, vcc
    v_cmp_eq_u32 vcc, 3, v15
    s_nop 1
    v_cndmask_b32 v35, 0, v14, vcc
    v_and_b32 v15, 1, v15
    v_cmp_eq_u32 vcc, 0, v15
    s_nop 1
    v_cndmask_b32 v36, 0, v14, vcc
    v_cmp_eq_u32 vcc, 1, v15
    s_nop 1
    v_cndmask_b32 v37, 0, v14, vcc
    v_cmp_eq_u32 s[92:93], 1, v2
    v_cmp_eq_u32 s[94:95], 2, v2
    v_cmp_eq_u32 s[96:97], 3, v2
    v_lshrrev_b32 v14, 1, v2
    v_lshlrev_b32 v38, 9, v14
    v_lshl_add_u32 v38, v1, 5, v38
    v_and_b32 v14, 1, v2
    v_lshl_add_u32 v38, v14, 4, v38
    v_lshlrev_b32 v39, 4, v0
    v_lshlrev_b32 v9, 2, v0
    s_waitcnt vmcnt(14)
    v_and_b32 v73, 0xffff0000, v60
    v_lshlrev_b32 v72, 16, v60
    v_and_b32 v75, 0xffff0000, v61
    v_lshlrev_b32 v74, 16, v61
    v_and_b32 v77, 0xffff0000, v62
    v_lshlrev_b32 v76, 16, v62
    v_and_b32 v79, 0xffff0000, v63
    v_lshlrev_b32 v78, 16, v63
    v_and_b32 v81, 0xffff0000, v64
    v_lshlrev_b32 v80, 16, v64
    v_and_b32 v83, 0xffff0000, v65
    v_lshlrev_b32 v82, 16, v65
    v_and_b32 v85, 0xffff0000, v66
    v_lshlrev_b32 v84, 16, v66
    v_and_b32 v87, 0xffff0000, v67
    v_lshlrev_b32 v86, 16, v67
    v_and_b32 v89, 0xffff0000, v68
    v_lshlrev_b32 v88, 16, v68
    v_add_f32 v14, v72, v73
    v_add_f32 v15, v74, v75
    v_add_f32 v14, v14, v76
    v_add_f32 v15, v15, v77
    v_add_f32 v14, v14, v78
    v_add_f32 v15, v15, v79
    v_add_f32 v14, v14, v80
    v_add_f32 v15, v15, v81
    v_add_f32 v14, v14, v82
    v_add_f32 v15, v15, v83
    v_add_f32 v14, v14, v84
    v_add_f32 v15, v15, v85
    v_add_f32 v14, v14, v86
    v_add_f32 v15, v15, v87
    v_add_f32 v14, v14, v88
    v_add_f32 v15, v15, v89
    v_add_f32 v14, v14, v15
    s_nop 1
    v_add_f32_dpp v14, v14, v14 row_ror:8 row_mask:0xf bank_mask:0xf
    s_nop 1
    v_add_f32_dpp v14, v14, v14 row_ror:4 row_mask:0xf bank_mask:0xf
    s_nop 1
    v_add_f32_dpp v14, v14, v14 row_ror:2 row_mask:0xf bank_mask:0xf
    s_nop 1
    v_add_f32_dpp v14, v14, v14 row_ror:1 row_mask:0xf bank_mask:0xf
    v_mov_b32 v15, v14
    s_nop 1
    v_permlane16_swap_b32 v14, v15
    v_add_f32 v14, v14, v15
    v_mul_f32 v14, 0x3ae38e39, v14
    v_mov_b32 v29, v14
    v_mov_b32 v15, 0
    v_mov_b32 v16, 0
    v_sub_f32 v72, v72, v14
    v_sub_f32 v73, v73, v14
    v_fmac_f32 v15, v72, v72
    v_fmac_f32 v16, v73, v73
    v_sub_f32 v74, v74, v14
    v_sub_f32 v75, v75, v14
    v_fmac_f32 v15, v74, v74
    v_fmac_f32 v16, v75, v75
    v_sub_f32 v76, v76, v14
    v_sub_f32 v77, v77, v14
    v_fmac_f32 v15, v76, v76
    v_fmac_f32 v16, v77, v77
    v_sub_f32 v78, v78, v14
    v_sub_f32 v79, v79, v14
    v_fmac_f32 v15, v78, v78
    v_fmac_f32 v16, v79, v79
    v_sub_f32 v80, v80, v14
    v_sub_f32 v81, v81, v14
    v_fmac_f32 v15, v80, v80
    v_fmac_f32 v16, v81, v81
    v_sub_f32 v82, v82, v14
    v_sub_f32 v83, v83, v14
    v_fmac_f32 v15, v82, v82
    v_fmac_f32 v16, v83, v83
    v_sub_f32 v84, v84, v14
    v_sub_f32 v85, v85, v14
    v_fmac_f32 v15, v84, v84
    v_fmac_f32 v16, v85, v85
    v_sub_f32 v86, v86, v14
    v_sub_f32 v87, v87, v14
    v_fmac_f32 v15, v86, v86
    v_fmac_f32 v16, v87, v87
    v_sub_f32 v88, v88, v14
    v_sub_f32 v89, v89, v14
    v_fmac_f32 v15, v88, v88
    v_fmac_f32 v16, v89, v89
    v_add_f32 v15, v15, v16
    s_nop 1
    v_add_f32_dpp v15, v15, v15 row_ror:8 row_mask:0xf bank_mask:0xf
    s_nop 1
    v_add_f32_dpp v15, v15, v15 row_ror:4 row_mask:0xf bank_mask:0xf
    s_nop 1
    v_add_f32_dpp v15, v15, v15 row_ror:2 row_mask:0xf bank_mask:0xf
    s_nop 1
    v_add_f32_dpp v15, v15, v15 row_ror:1 row_mask:0xf bank_mask:0xf
    v_mov_b32 v16, v15
    s_nop 1
    v_permlane16_swap_b32 v15, v16
    v_add_f32 v15, v15, v16
    v_mul_f32 v15, 0x3ae38e39, v15
    v_cvt_pk_bf16_f32 v15, v15, v15
    v_and_b32 v15, 0xffff0000, v15
    v_add_f32 v15, 0x3727c5ac, v15
    v_cvt_pk_bf16_f32 v15, v15, v15
    v_and_b32 v15, 0xffff0000, v15
    v_sqrt_f32 v15, v15
    s_nop 0
    v_cvt_pk_bf16_f32 v15, v15, v15
    v_and_b32 v15, 0xffff0000, v15
    v_rcp_f32 v15, v15
    v_cvt_pk_bf16_f32 v14, v14, v14
    v_and_b32 v14, 0xffff0000, v14
    s_waitcnt vmcnt(11)
    s_mul_i32 s8, s3, 768
    s_add_u32 s8, s8, 69632
    v_mul_u32_u24 v16, 384, v4
    v_lshl_add_u32 v16, v5, 2, v16
    v_add_u32 v16, s8, v16
    v_lshlrev_b32 v69, 16, v69
    v_sub_f32 v69, v69, v14
    v_cvt_pk_bf16_f32 v69, v69, v69
    v_and_b32 v69, 0xffff0000, v69
    v_mul_f32 v69, v69, v15
    v_cvt_pk_bf16_f32 v69, v69, v69
    ds_write_b32 v16, v69 offset:0
    v_lshlrev_b32 v70, 16, v70
    v_sub_f32 v70, v70, v14
    v_cvt_pk_bf16_f32 v70, v70, v70
    v_and_b32 v70, 0xffff0000, v70
    v_mul_f32 v70, v70, v15
    v_cvt_pk_bf16_f32 v70, v70, v70
    ds_write_b32 v16, v70 offset:128
    v_lshlrev_b32 v71, 16, v71
    v_sub_f32 v71, v71, v14
    v_cvt_pk_bf16_f32 v71, v71, v71
    v_and_b32 v71, 0xffff0000, v71
    v_mul_f32 v71, v71, v15
    v_cvt_pk_bf16_f32 v71, v71, v71
    ds_write_b32 v16, v71 offset:256
    v_lshrrev_b32 v17, 3, v1
    v_mul_u32_u24 v17, 384, v17
    v_lshl_add_u32 v17, v2, 2, v17
    s_lshl_b32 s9, s3, 4
    s_add_u32 s8, s8, s9
    v_add_u32 v17, s8, v17
    s_waitcnt lgkmcnt(0)
    s_add_u32 s78, s78, 1
    s_and_b32 s76, s78, 0x3ff
    v_mov_b32 v30, s76
    s_and_b32 s75, s78, 63
    s_getreg_b32 s72, hwreg(HW_REG_XCC_ID)
    s_and_b32 s72, s72, 15
    s_lshl_b32 s8, s78, 4
    s_or_b32 s72, s72, s8
    s_cmp_lg_u32 s3, 0
    s_cbranch_scc1 L_noxid
    s_lshl_b32 s8, s5, 2
    s_add_u32 s8, s8, s99
    s_add_u32 s8, s8, 516096
    v_mov_b32 v65, s72
    v_mov_b32 v66, 0
    s_mov_b64 exec, 1
    buffer_store_dword v65, v66, s[64:67], s8 offen sc1
    s_mov_b64 exec, -1
L_noxid:
    ds_read_b32 v60, v17 offset:0
    ds_read_b32 v61, v17 offset:64
    ds_read_b32 v62, v17 offset:128
    ds_read_b32 v63, v17 offset:192
    ds_read_b32 v64, v17 offset:256
    s_waitcnt lgkmcnt(0)
    v_and_b32 v72, v60, v32
    v_and_b32 v73, v60, v33
    v_and_b32 v74, v60, v34
    v_and_b32 v75, v60, v35
    v_and_b32 v76, v61, v32
    v_and_b32 v77, v61, v33
    v_and_b32 v78, v61, v34
    v_and_b32 v79, v61, v35
    v_and_b32 v80, v62, v32
    v_and_b32 v81, v62, v33
    v_and_b32 v82, v62, v34
    v_and_b32 v83, v62, v35
    v_and_b32 v84, v63, v32
    v_and_b32 v85, v63, v33
    v_and_b32 v86, v63, v34
    v_and_b32 v87, v63, v35
    v_and_b32 v88, v64, v32
    v_and_b32 v89, v64, v33
    v_and_b32 v90, v64, v34
    v_and_b32 v91, v64, v35
    s_waitcnt vmcnt(10)
    v_mfma_f32_16x16x32_bf16 v[96:99], v[72:75], v[40:43], 0
    s_waitcnt vmcnt(9)
    v_mfma_f32_16x16x32_bf16 v[96:99], v[76:79], v[44:47], v[96:99]
    s_waitcnt vmcnt(8)
    v_mfma_f32_16x16x32_bf16 v[96:99], v[80:83], v[48:51], v[96:99]
    s_waitcnt vmcnt(7)
    v_mfma_f32_16x16x32_bf16 v[96:99], v[84:87], v[52:55], v[96:99]
    s_waitcnt vmcnt(6)
    v_mfma_f32_16x16x32_bf16 v[96:99], v[88:91], v[56:59], v[96:99]
    s_lshl_b32 s8, s3, 10
    s_add_u32 s8, s8, 65536
    v_add_u32 v18, s8, v39
    v_add_u32 v19, 65536, v39
    s_nop 3
    ds_write_b128 v18, v[96:99]
    s_lshr_b32 s8, s3, 1
    s_lshl_b32 s8, s8, 5
    s_and_b32 s9, s3, 1
    s_lshl_b32 s9, s9, 3
    s_add_u32 s8, s8, s9
    s_mov_b64 s[62:63], 0x00ff00ff
    s_lshl_b64 s[62:63], s[62:63], s8
    s_waitcnt lgkmcnt(0)
    s_barrier
    s_mov_b64 exec, s[62:63]
    ds_read_b128 v[72:75], v19 offset:0
    ds_read_b128 v[76:79], v19 offset:1024
    ds_read_b128 v[80:83], v19 offset:2048
    ds_read_b128 v[84:87], v19 offset:3072
    s_waitcnt lgkmcnt(2)
    v_pk_add_f32 v[72:73], v[72:73], v[76:77]
    v_pk_add_f32 v[74:75], v[74:75], v[78:79]
    s_waitcnt lgkmcnt(0)
    v_pk_add_f32 v[80:81], v[80:81], v[84:85]
    v_pk_add_f32 v[82:83], v[82:83], v[86:87]
    v_pk_add_f32 v[72:73], v[72:73], v[80:81]
    v_pk_add_f32 v[74:75], v[74:75], v[82:83]
    v_bfi_b32 v72, 63, v30, v72
    v_bfi_b32 v73, 63, v30, v73
    v_bfi_b32 v74, 63, v30, v74
    v_bfi_b32 v75, 63, v30, v75
    buffer_store_dwordx4 v[72:75], v38, s[64:67], s13 offen sc1
    s_mov_b64 exec, -1
    buffer_load_dwordx4 v12, s[40:43], s14 offen offset:2048 nt lds
    s_waitcnt vmcnt(7)
    buffer_load_dwordx4 v13, s[40:43], s14 offen offset:3072 nt lds
    s_add_u32 s14, s14, 131072
    s_waitcnt vmcnt(7)
    buffer_load_dwordx4 v[168:171], v236, s[52:55], s81 offen offset:0 nt
    s_add_u32 s101, s100, 8192
    s_mov_b32 m0, s101
    s_waitcnt vmcnt(7)
    buffer_load_dwordx4 v10, s[40:43], s14 offen offset:0 nt lds
    s_waitcnt vmcnt(7)
    buffer_load_dwordx4 v11, s[40:43], s14 offen offset:1024 nt lds
    s_waitcnt vmcnt(7)
    buffer_load_dwordx4 v[172:175], v236, s[52:55], s81 offen offset:1152 nt
    s_waitcnt vmcnt(7)
    buffer_load_dwordx4 v12, s[40:43], s14 offen offset:2048 nt lds
    s_waitcnt vmcnt(7)
    buffer_load_dwordx4 v13, s[40:43], s14 offen offset:3072 nt lds
    s_add_u32 s14, s14, 131072
    s_waitcnt vmcnt(7)
    buffer_load_dwordx4 v[176:179], v236, s[52:55], s81 offen offset:128 nt
    s_add_u32 s101, s100, 12288
    s_mov_b32 m0, s101
    s_waitcnt vmcnt(7)
    buffer_load_dwordx4 v10, s[40:43], s14 offen offset:0 nt lds
    s_waitcnt vmcnt(7)
    buffer_load_dwordx4 v11, s[40:43], s14 offen offset:1024 nt lds
    s_waitcnt vmcnt(7)
    buffer_load_dwordx4 v[180:183], v236, s[52:55], s81 offen offset:1280 nt
    s_waitcnt vmcnt(7)
    buffer_load_dwordx4 v12, s[40:43], s14 offen offset:2048 nt lds
    s_waitcnt vmcnt(7)
    buffer_load_dwordx4 v13, s[40:43], s14 offen offset:3072 nt lds
    s_add_u32 s14, s14, 131072
    s_waitcnt vmcnt(7)
    buffer_load_dwordx4 v[184:187], v236, s[52:55], s81 offen offset:256 nt
    s_lshr_b32 s8, s3, 1
    s_lshl_b32 s9, s6, 1
    s_add_u32 s8, s8, s9
    s_lshl_b32 s8, s8, 13
    s_lshr_b32 s9, s7, 3
    s_lshl_b32 s9, s9, 9
    s_add_u32 s8, s8, s9
    s_and_b32 s9, s3, 1
    s_lshl_b32 s9, s9, 8
    s_add_u32 s8, s8, s9
    s_add_u32 s8, s8, 262144
    s_add_u32 s8, s8, s98
    s_add_u32 s9, s8, 4096
    s_add_u32 s10, s99, 516096
    v_lshlrev_b32 v50, 2, v5
    buffer_load_dword v49, v50, s[64:67], s10 offen sc1
    buffer_load_dword v40, v9, s[64:67], s8 offen offset:0 sc1
    buffer_load_dword v41, v9, s[64:67], s8 offen offset:1024 sc1
    buffer_load_dword v42, v9, s[64:67], s8 offen offset:2048 sc1
    buffer_load_dword v43, v9, s[64:67], s8 offen offset:3072 sc1
    buffer_load_dword v44, v9, s[64:67], s9 offen offset:0 sc1
    buffer_load_dword v45, v9, s[64:67], s9 offen offset:1024 sc1
    buffer_load_dword v46, v9, s[64:67], s9 offen offset:2048 sc1
    buffer_load_dword v47, v9, s[64:67], s9 offen offset:3072 sc1
    s_waitcnt vmcnt(15)
    buffer_load_dwordx4 v[104:107], v39, s[44:47], s15 offen offset:0 nt
    s_waitcnt vmcnt(15)
    buffer_load_dwordx4 v[108:111], v39, s[44:47], s15 offen offset:1024 nt
    s_waitcnt vmcnt(15)
    buffer_load_dwordx4 v[188:191], v236, s[52:55], s81 offen offset:1408 nt
    s_waitcnt vmcnt(15)
    buffer_load_dwordx4 v[112:115], v39, s[44:47], s15 offen offset:2048 nt
    s_waitcnt vmcnt(15)
    buffer_load_dwordx4 v[116:119], v39, s[44:47], s15 offen offset:3072 nt
    s_add_u32 s15, s15, 131072
    s_waitcnt vmcnt(15)
    buffer_load_dwordx4 v[192:195], v236, s[52:55], s82 offen offset:0 nt
    s_waitcnt vmcnt(15)
    buffer_load_dwordx4 v[120:123], v39, s[44:47], s15 offen offset:0 nt
    s_waitcnt vmcnt(15)
    buffer_load_dwordx4 v[124:127], v39, s[44:47], s15 offen offset:1024 nt
    s_waitcnt vmcnt(15)
    buffer_load_dwordx4 v[196:199], v236, s[52:55], s82 offen offset:1152 nt
    s_waitcnt vmcnt(9)
    s_branch L_qchk
L_qretry:
    s_sleep 1
    buffer_load_dword v49, v50, s[64:67], s10 offen sc1
    buffer_load_dword v40, v9, s[64:67], s8 offen offset:0 sc1
    buffer_load_dword v41, v9, s[64:67], s8 offen offset:1024 sc1
    buffer_load_dword v42, v9, s[64:67], s8 offen offset:2048 sc1
    buffer_load_dword v43, v9, s[64:67], s8 offen offset:3072 sc1
    buffer_load_dword v44, v9, s[64:67], s9 offen offset:0 sc1
    buffer_load_dword v45, v9, s[64:67], s9 offen offset:1024 sc1
    buffer_load_dword v46, v9, s[64:67], s9 offen offset:2048 sc1
    buffer_load_dword v47, v9, s[64:67], s9 offen offset:3072 sc1
    s_waitcnt vmcnt(0)
L_qchk:
    v_xor_b32 v40, s75, v40
    v_xor_b32 v41, s75, v41
    v_xor_b32 v42, s75, v42
    v_xor_b32 v43, s75, v43
    v_xor_b32 v44, s75, v44
    v_xor_b32 v45, s75, v45
    v_xor_b32 v46, s75, v46
    v_xor_b32 v47, s75, v47
    v_or_b32 v48, v40, v41
    v_or3_b32 v48, v48, v42, v43
    v_or3_b32 v48, v48, v44, v45
    v_or3_b32 v48, v48, v46, v47
    v_xor_b32 v49, s72, v49
    v_cmp_lt_u32 vcc, 15, v49
    s_nop 1
    v_cndmask_b32 v51, 0, 1, vcc
    v_or_b32 v48, v48, v51
    v_and_b32 v48, 63, v48
    v_cmp_ne_u32 vcc, 0, v48
    s_cbranch_vccz L_ok_1
    s_add_u32 s79, s79, 1
    s_cmp_lt_u32 s79, 4000000
    s_cbranch_scc1 L_qretry
L_ok_1:
    v_cmp_ne_u32 vcc, 0, v49
    s_nop 0
    s_cmp_eq_u64 vcc, 0
    s_cselect_b32 s61, 1, 0
    s_mov_b32 s72, 0
    s_add_u32 s60, s99, 516352
    v_mov_b32 v238, s78
    s_lshl_b32 s8, s5, 2
    v_mov_b32 v239, s8
    v_add_f32 v40, v40, v41
    v_add_f32 v42, v42, v43
    v_add_f32 v44, v44, v45
    v_add_f32 v46, v46, v47
    v_add_f32 v40, v40, v42
    v_add_f32 v44, v44, v46
    v_add_f32 v40, v40, v44
    v_cvt_pk_bf16_f32 v40, v40, v40
    s_lshl_b32 s8, s3, 7
    s_add_u32 s8, s8, 72704
    v_lshlrev_b32 v14, 1, v0
    v_add_u32 v14, s8, v14
    ds_write_b16 v14, v40
    v_and_b32 v14, 1, v1
    v_lshlrev_b32 v14, 8, v14
    v_lshl_add_u32 v14, v2, 4, v14
    v_add_u32 v14, 72704, v14
    v_add_u32 v20, 0, v2
    v_xor_b32 v20, v20, v1
    v_lshlrev_b32 v20, 4, v20
    v_lshl_add_u32 v20, v1, 8, v20
    v_add_u32 v20, s100, v20
    v_add_u32 v21, 4, v2
    v_xor_b32 v21, v21, v1
    v_lshlrev_b32 v21, 4, v21
    v_lshl_add_u32 v21, v1, 8, v21
    v_add_u32 v21, s100, v21
    v_add_u32 v22, 8, v2
    v_xor_b32 v22, v22, v1
    v_lshlrev_b32 v22, 4, v22
    v_lshl_add_u32 v22, v1, 8, v22
    v_add_u32 v22, s100, v22
    v_add_u32 v23, 12, v2
    v_xor_b32 v23, v23, v1
    v_lshlrev_b32 v23, 4, v23
    v_lshl_add_u32 v23, v1, 8, v23
    v_add_u32 v23, s100, v23
    s_waitcnt lgkmcnt(0)
    s_barrier
    ds_read_b128 v[40:43], v14 offset:0
    ds_read_b128 v[44:47], v14 offset:64
    ds_read_b128 v[48:51], v14 offset:128
    ds_read_b128 v[52:55], v14 offset:192
    ds_read_b128 v[56:59], v20 offset:0
    ds_read_b128 v[60:63], v21 offset:0
    ds_read_b128 v[64:67], v22 offset:0
    ds_read_b128 v[68:71], v23 offset:0
    ds_read_b128 v[72:75], v20 offset:4096
    ds_read_b128 v[76:79], v21 offset:4096
    ds_read_b128 v[80:83], v22 offset:4096
    ds_read_b128 v[84:87], v23 offset:4096
    s_waitcnt lgkmcnt(4)
    v_mfma_f32_16x16x32_bf16 v[88:91], v[40:43], v[56:59], 0
    v_mfma_f32_16x16x32_bf16 v[88:91], v[44:47], v[60:63], v[88:91]
    v_mfma_f32_16x16x32_bf16 v[88:91], v[48:51], v[64:67], v[88:91]
    v_mfma_f32_16x16x32_bf16 v[88:91], v[52:55], v[68:71], v[88:91]
    s_nop 1
    ds_read_b128 v[56:59], v20 offset:8192
    ds_read_b128 v[60:63], v21 offset:8192
    ds_read_b128 v[64:67], v22 offset:8192
    ds_read_b128 v[68:71], v23 offset:8192
    s_waitcnt vmcnt(7)
    buffer_load_dwordx4 v[128:131], v39, s[44:47], s15 offen offset:2048 nt
    s_waitcnt lgkmcnt(4)
    v_mfma_f32_16x16x32_bf16 v[92:95], v[40:43], v[72:75], 0
    v_mfma_f32_16x16x32_bf16 v[92:95], v[44:47], v[76:79], v[92:95]
    v_mfma_f32_16x16x32_bf16 v[92:95], v[48:51], v[80:83], v[92:95]
    v_mfma_f32_16x16x32_bf16 v[92:95], v[52:55], v[84:87], v[92:95]
    s_nop 1
    ds_read_b128 v[72:75], v20 offset:12288
    ds_read_b128 v[76:79], v21 offset:12288
    ds_read_b128 v[80:83], v22 offset:12288
    ds_read_b128 v[84:87], v23 offset:12288
    s_waitcnt vmcnt(7)
    buffer_load_dwordx4 v[132:135], v39, s[44:47], s15 offen offset:3072 nt
    s_add_u32 s15, s15, 131072
    s_waitcnt vmcnt(7)
    buffer_load_dwordx4 v[200:203], v236, s[52:55], s82 offen offset:128 nt
    s_waitcnt lgkmcnt(4)
    v_mfma_f32_16x16x32_bf16 v[96:99], v[40:43], v[56:59], 0
    v_mfma_f32_16x16x32_bf16 v[96:99], v[44:47], v[60:63], v[96:99]
    v_mfma_f32_16x16x32_bf16 v[96:99], v[48:51], v[64:67], v[96:99]
    v_mfma_f32_16x16x32_bf16 v[96:99], v[52:55], v[68:71], v[96:99]
    s_waitcnt vmcnt(7)
    buffer_load_dwordx4 v[136:139], v39, s[44:47], s15 offen offset:0 nt
    s_waitcnt lgkmcnt(0)
    v_mfma_f32_16x16x32_bf16 v[100:103], v[40:43], v[72:75], 0
    v_mfma_f32_16x16x32_bf16 v[100:103], v[44:47], v[76:79], v[100:103]
    v_mfma_f32_16x16x32_bf16 v[100:103], v[48:51], v[80:83], v[100:103]
    v_mfma_f32_16x16x32_bf16 v[100:103], v[52:55], v[84:87], v[100:103]
    s_waitcnt vmcnt(7)
    buffer_load_dwordx4 v[140:143], v39, s[44:47], s15 offen offset:1024 nt
    s_waitcnt vmcnt(7)
    buffer_load_dwordx4 v[204:207], v236, s[52:55], s82 offen offset:1280 nt
    v_cndmask_b32 v24, v88, v92, s[92:93]
    v_cndmask_b32 v25, v89, v93, s[92:93]
    v_cndmask_b32 v24, v24, v96, s[94:95]
    v_cndmask_b32 v25, v25, v97, s[94:95]
    v_cndmask_b32 v24, v24, v100, s[96:97]
    v_cndmask_b32 v25, v25, v101, s[96:97]
    v_cvt_pk_bf16_f32 v26, v24, v25
    v_lshlrev_b32 v24, 16, v26
    v_and_b32 v25, 0xffff0000, v26
    v_mul_f32 v24, 0x3db504f3, v24
    v_mul_f32 v25, 0x3db504f3, v25
    v_cvt_pk_bf16_f32 v26, v24, v25
    v_lshlrev_b32 v24, 16, v26
    v_and_b32 v25, 0xffff0000, v26
    v_mov_b32 v26, v24
    v_mov_b32 v27, v25
    s_nop 0
    v_max_f32_dpp v26, v26, v26 row_ror:8 row_mask:0xf bank_mask:0xf
    v_max_f32_dpp v27, v27, v27 row_ror:8 row_mask:0xf bank_mask:0xf
    s_nop 0
    v_max_f32_dpp v26, v26, v26 row_ror:4 row_mask:0xf bank_mask:0xf
    v_max_f32_dpp v27, v27, v27 row_ror:4 row_mask:0xf bank_mask:0xf
    s_nop 0
    v_max_f32_dpp v26, v26, v26 row_ror:2 row_mask:0xf bank_mask:0xf
    v_max_f32_dpp v27, v27, v27 row_ror:2 row_mask:0xf bank_mask:0xf
    s_nop 0
    v_max_f32_dpp v26, v26, v26 row_ror:1 row_mask:0xf bank_mask:0xf
    v_max_f32_dpp v27, v27, v27 row_ror:1 row_mask:0xf bank_mask:0xf
    v_mov_b32 v14, v26
    v_mov_b32 v15, v27
    s_nop 0
    v_permlane16_swap_b32 v26, v14
    v_permlane16_swap_b32 v27, v15
    v_max_f32 v26, v26, v14
    v_max_f32 v27, v27, v15
    v_mov_b32 v14, v26
    v_mov_b32 v15, v27
    s_nop 0
    v_permlane32_swap_b32 v26, v14
    v_permlane32_swap_b32 v27, v15
    v_max_f32 v26, v26, v14
    v_max_f32 v27, v27, v15
    s_lshl_b32 s8, s3, 3
    s_add_u32 s8, s8, 75264
    v_mov_b32 v14, s8
    v_mov_b32 v16, 75264
    ds_write_b64 v14, v[26:27]
    s_waitcnt vmcnt(7)
    buffer_load_dwordx4 v[144:147], v39, s[44:47], s15 offen offset:2048 nt
    s_waitcnt lgkmcnt(0)
    s_barrier
    ds_read_b128 v[40:43], v16
    ds_read_b128 v[44:47], v16 offset:16
    s_waitcnt lgkmcnt(0)
    v_max3_f32 v26, v40, v42, v44
    v_max3_f32 v27, v41, v43, v45
    v_max_f32 v26, v26, v46
    v_max_f32 v27, v27, v47
    v_sub_f32 v24, v24, v26
    v_sub_f32 v25, v25, v27
    v_mul_f32 v24, 0x3fb8aa3b, v24
    v_mul_f32 v25, 0x3fb8aa3b, v25
    v_exp_f32 v24, v24
    v_exp_f32 v25, v25
    s_lshl_b32 s8, s3, 9
    s_add_u32 s8, s8, 73216
    v_and_b32 v15, 3, v0
    v_lshlrev_b32 v15, 6, v15
    v_lshrrev_b32 v17, 2, v0
    v_lshl_add_u32 v15, v17, 2, v15
    v_add_u32 v15, s8, v15
    v_cvt_pk_bf16_f32 v40, v24, v24
    v_cvt_pk_bf16_f32 v41, v25, v25
    ds_write_b32 v15, v40
    ds_write_b32 v15, v41 offset:256
    v_lshrrev_b32 v17, 3, v1
    v_lshlrev_b32 v17, 8, v17
    v_lshl_add_u32 v17, v2, 6, v17
    v_add_u32 v17, s8, v17
    v_add_f32_dpp v24, v24, v24 row_ror:8 row_mask:0xf bank_mask:0xf
    v_add_f32_dpp v25, v25, v25 row_ror:8 row_mask:0xf bank_mask:0xf
    s_nop 0
    v_add_f32_dpp v24, v24, v24 row_ror:4 row_mask:0xf bank_mask:0xf
    v_add_f32_dpp v25, v25, v25 row_ror:4 row_mask:0xf bank_mask:0xf
    s_nop 0
    v_add_f32_dpp v24, v24, v24 row_ror:2 row_mask:0xf bank_mask:0xf
    v_add_f32_dpp v25, v25, v25 row_ror:2 row_mask:0xf bank_mask:0xf
    s_nop 0
    v_add_f32_dpp v24, v24, v24 row_ror:1 row_mask:0xf bank_mask:0xf
    v_add_f32_dpp v25, v25, v25 row_ror:1 row_mask:0xf bank_mask:0xf
    v_mov_b32 v42, v24
    v_mov_b32 v43, v25
    s_nop 0
    v_permlane16_swap_b32 v24, v42
    v_permlane16_swap_b32 v25, v43
    v_add_f32 v24, v24, v42
    v_add_f32 v25, v25, v43
    v_mov_b32 v42, v24
    v_mov_b32 v43, v25
    s_nop 0
    v_permlane32_swap_b32 v24, v42
    v_permlane32_swap_b32 v25, v43
    v_add_f32 v24, v24, v42
    v_add_f32 v25, v25, v43
    ds_write_b64 v14, v[24:25] offset:32
    s_waitcnt lgkmcnt(0)
    ds_read_b128 v[240:243], v17 offset:0
    ds_read_b128 v[244:247], v17 offset:16
    ds_read_b128 v[248:251], v17 offset:32
    ds_read_b128 v[252:255], v17 offset:48
    s_waitcnt vmcnt(7)
    buffer_load_dwordx4 v[148:151], v39, s[44:47], s15 offen offset:3072 nt
    s_add_u32 s15, s15, 131072
    s_waitcnt vmcnt(7)
    buffer_load_dwordx4 v[208:211], v236, s[52:55], s82 offen offset:256 nt
    s_waitcnt lgkmcnt(0)
    v_and_b32 v40, v240, v32
    v_and_b32 v41, v240, v33
    v_and_b32 v42, v240, v34
    v_and_b32 v43, v240, v35
    v_and_b32 v44, v241, v32
    v_and_b32 v45, v241, v33
    v_and_b32 v46, v241, v34
    v_and_b32 v47, v241, v35
    v_and_b32 v48, v242, v32
    v_and_b32 v49, v242, v33
    v_and_b32 v50, v242, v34
    v_and_b32 v51, v242, v35
    v_and_b32 v52, v243, v32
    v_and_b32 v53, v243, v33
    v_and_b32 v54, v243, v34
    v_and_b32 v55, v243, v35
    s_waitcnt vmcnt(7)
    buffer_load_dwordx4 v[152:155], v39, s[44:47], s15 offen offset:0 nt
    v_and_b32 v56, v244, v32
    v_and_b32 v57, v244, v33
    v_and_b32 v58, v244, v34
    v_and_b32 v59, v244, v35
    v_and_b32 v60, v245, v32
    v_and_b32 v61, v245, v33
    v_and_b32 v62, v245, v34
    v_and_b32 v63, v245, v35
    v_and_b32 v64, v246, v32
    v_and_b32 v65, v246, v33
    v_and_b32 v66, v246, v34
    v_and_b32 v67, v246, v35
    v_and_b32 v68, v247, v32
    v_and_b32 v69, v247, v33
    v_and_b32 v70, v247, v34
    v_and_b32 v71, v247, v35
    s_waitcnt vmcnt(7)
    buffer_load_dwordx4 v[156:159], v39, s[44:47], s15 offen offset:1024 nt
    s_waitcnt vmcnt(7)
    buffer_load_dwordx4 v[212:215], v236, s[52:55], s82 offen offset:1408 nt
    v_and_b32 v72, v248, v32
    v_and_b32 v73, v248, v33
    v_and_b32 v74, v248, v34
    v_and_b32 v75, v248, v35
    v_and_b32 v76, v249, v32
    v_and_b32 v77, v249, v33
    v_and_b32 v78, v249, v34
    v_and_b32 v79, v249, v35
    v_and_b32 v80, v250, v32
    v_and_b32 v81, v250, v33
    v_and_b32 v82, v250, v34
    v_and_b32 v83, v250, v35
    v_and_b32 v84, v251, v32
    v_and_b32 v85, v251, v33
    v_and_b32 v86, v251, v34
    v_and_b32 v87, v251, v35
    s_waitcnt vmcnt(7)
    buffer_load_dwordx4 v[160:163], v39, s[44:47], s15 offen offset:2048 nt
    v_and_b32 v88, v252, v32
    v_and_b32 v89, v252, v33
    v_and_b32 v90, v252, v34
    v_and_b32 v91, v252, v35
    v_and_b32 v92, v253, v32
    v_and_b32 v93, v253, v33
    v_and_b32 v94, v253, v34
    v_and_b32 v95, v253, v35
    v_and_b32 v96, v254, v32
    v_and_b32 v97, v254, v33
    v_and_b32 v98, v254, v34
    v_and_b32 v99, v254, v35
    v_and_b32 v100, v255, v32
    v_and_b32 v101, v255, v33
    v_and_b32 v102, v255, v34
    v_and_b32 v103, v255, v35
    s_waitcnt vmcnt(7)
    buffer_load_dwordx4 v[164:167], v39, s[44:47], s15 offen offset:3072 nt
    s_add_u32 s15, s15, 131072
    s_barrier
    s_cmp_lg_u32 s3, 1
    s_cbranch_scc1 L_noml
    ds_read_b128 v[240:243], v16 offset:32
    ds_read_b128 v[244:247], v16 offset:48
    s_waitcnt lgkmcnt(0)
    v_add_f32 v240, v240, v242
    v_add_f32 v244, v244, v246
    v_add_f32 v241, v241, v243
    v_add_f32 v245, v245, v247
    v_add_f32 v249, v240, v244
    v_add_f32 v251, v241, v245
    v_mov_b32 v248, v26
    v_mov_b32 v250, v27
    v_bfi_b32 v248, s77, v30, v248
    v_bfi_b32 v249, s77, v30, v249
    v_bfi_b32 v250, s77, v30, v250
    v_bfi_b32 v251, s77, v30, v251
    s_and_b32 s8, s6, 1
    s_lshl_b32 s8, s8, 11
    s_lshl_b32 s9, s7, 7
    s_add_u32 s8, s8, s9
    s_add_u32 s8, s8, 327680
    s_add_u32 s8, s8, s99
    s_mov_b64 exec, 0xff
    buffer_store_dwordx4 v[248:251], v39, s[64:67], s8 offen
    s_cmp_lg_u32 s61, 0
    s_cbranch_scc1 L_pub_2
    buffer_store_dwordx4 v[248:251], v39, s[64:67], s8 offen sc1
L_pub_2:
    s_mov_b64 exec, -1
L_noml:
    s_lshl_b32 s13, s6, 14
    s_lshl_b32 s9, s7, 9
    s_add_u32 s13, s13, s9
    s_add_u32 s13, s13, 294912
    s_add_u32 s13, s13, s98
    v_lshrrev_b32 v14, 1, v2
    v_mul_u32_u24 v14, 7680, v14
    v_add_u32 v28, v14, v38
    s_cmp_lt_u32 s5, 18
    s_cbranch_scc1 L_F
    s_mov_b32 s10, s74
    s_mov_b32 s11, s73
    s_bfe_u32 s8, s11, 0x10001
    s_lshl_b32 s8, s8, 11
    s_add_u32 s86, s8, 327680
    s_add_u32 s86, s86, s99
    s_add_u32 s86, s86, s72
    v_lshlrev_b32 v25, 7, v1
    s_sub_u32 s48, s10, 5
    s_and_b32 s8, s48, 15
    s_mul_i32 s87, s8, 11
    s_lshr_b32 s87, s87, 5
    s_mul_i32 s9, s87, 3
    s_sub_u32 s49, s8, s9
    s_mul_i32 s12, s4, 3
    s_add_u32 s12, s12, s87
    s_mul_i32 s8, s12, 192
    s_mul_i32 s9, s3, 48
    s_add_u32 s8, s8, s9
    s_mul_i32 s8, s8, 1152
    s_mul_i32 s9, s49, 384
    s_add_u32 s50, s8, s9
    s_add_u32 s51, s50, 18432
    s_add_u32 s84, s50, 36864
    s_mov_b32 s44, s32
    s_and_b32 s45, s33, 0xffff
    s_mov_b32 s46, 5308416
    s_mov_b32 s47, 0x00020000
    s_cmp_lt_u32 s10, 5
    s_cselect_b32 s50, 0x7fff0000, s50
    s_cselect_b32 s51, 0x7fff0000, s51
    s_cselect_b32 s84, 0x7fff0000, s84
    s_mul_i32 s100, s3, 6144
    s_add_u32 s100, s100, 20480
    s_add_u32 s101, s100, 0
    s_mov_b32 m0, s101
    s_nop 0
    buffer_load_dwordx4 v236, s[44:47], s50 offen offset:0 nt lds
    s_add_u32 s101, s100, -128
    s_mov_b32 m0, s101
    s_nop 0
    buffer_load_dwordx4 v236, s[44:47], s50 offen offset:1152 nt lds
    s_add_u32 s101, s100, 1920
    s_mov_b32 m0, s101
    s_nop 0
    buffer_load_dwordx4 v236, s[44:47], s50 offen offset:128 nt lds
    s_add_u32 s101, s100, 1792
    s_mov_b32 m0, s101
    s_nop 0
    buffer_load_dwordx4 v236, s[44:47], s50 offen offset:1280 nt lds
    s_add_u32 s101, s100, 3840
    s_mov_b32 m0, s101
    s_nop 0
    buffer_load_dwordx4 v236, s[44:47], s50 offen offset:256 nt lds
    s_add_u32 s101, s100, 3712
    s_mov_b32 m0, s101
    s_nop 0
    buffer_load_dwordx4 v236, s[44:47], s50 offen offset:1408 nt lds
    v_bfe_u32 v14, v1, 2, 1
    v_lshrrev_b32 v15, 3, v1
    v_lshlrev_b32 v21, 5, v14
    v_lshl_add_u32 v21, v15, 3, v21
    v_lshl_add_u32 v21, v2, 1, v21
    v_lshlrev_b32 v21, 2, v21
    v_lshlrev_b32 v3, 4, v14
    v_lshl_add_u32 v3, v15, 1, v3
    v_lshrrev_b32 v14, 1, v2
    v_add_u32 v3, v3, v14
    v_and_b32 v14, 1, v2
    v_lshl_add_u32 v3, v14, 5, v3
    v_lshlrev_b32 v3, 2, v3
    s_mul_i32 s8, s3, 3072
    v_lshrrev_b32 v14, 3, v1
    v_mul_u32_u24 v22, 1536, v14
    v_and_b32 v14, 1, v2
    v_mul_u32_u24 v14, 768, v14
    v_add_u32 v22, v22, v14
    v_and_b32 v14, 7, v1
    v_lshl_add_u32 v22, v14, 5, v22
    v_add_u32 v22, s8, v22
    v_lshrrev_b32 v14, 3, v1
    v_lshrrev_b32 v15, 1, v2
    v_cmp_eq_u32 vcc, v14, v15
    v_add_u32 v14, 16384, v39
    s_nop 0
    v_cndmask_b32 v22, v14, v22, vcc
    s_mul_i32 s8, s3, 384
    v_add_u32 v23, s8, v39
    s_lshl_b32 s8, s80, 1
    s_and_b32 s9, s3, 1
    s_add_u32 s8, s8, s9
    s_lshl_b32 s8, s8, 18
    s_mul_i32 s85, s11, 768
    s_add_u32 s85, s85, s8
    s_lshr_b32 s9, s3, 1
    s_mul_i32 s9, s9, 384
    s_add_u32 s85, s85, s9
    s_add_u32 s85, s85, 331776
    s_lshl_b32 s8, s3, 6
    s_add_u32 s8, s8, 78464
    v_lshlrev_b32 v6, 2, v1
    v_add_u32 v6, s8, v6
    v_lshlrev_b32 v7, 5, v4
    v_add_u32 v7, s8, v7
    s_lshl_b32 s83, s11, 13
    s_lshl_b32 s8, s3, 7
    s_add_u32 s83, s83, s8
    s_add_u32 s83, s83, 294912
    s_add_u32 s83, s83, s98
    s_add_u32 s83, s83, s72
    v_lshlrev_b32 v26, 12, v4
    v_lshl_add_u32 v26, v5, 2, v26
    s_lshl_b32 s8, s49, 1
    s_and_b32 s9, s3, 1
    s_add_u32 s8, s8, s9
    s_lshl_b32 s8, s8, 18
    s_mul_i32 s40, s12, 768
    s_add_u32 s40, s40, s8
    s_lshr_b32 s9, s3, 1
    s_mul_i32 s9, s9, 384
    s_add_u32 s40, s40, s9
    s_add_u32 s40, s40, 356352
    s_add_u32 s12, s99, s72
    s_lshl_b32 s41, s87, 10
    s_add_u32 s41, s41, s12
    s_add_u32 s41, s41, 471040
    v_and_b32 v10, 7, v0
    v_lshlrev_b32 v10, 7, v10
    s_mul_i32 s9, s3, 192
    s_add_u32 s12, s12, s9
    s_mul_i32 s56, s87, 18432
    s_add_u32 s56, s56, s12
    s_add_u32 s56, s56, 385024
    s_add_u32 s57, s56, 6144
    s_add_u32 s58, s56, 12288
    s_mul_i32 s88, s87, 9216
    s_add_u32 s88, s88, s12
    s_add_u32 s88, s88, 442368
    s_add_u32 s89, s88, 4608
    v_mul_u32_u24 v11, 768, v2
    v_lshl_add_u32 v11, v1, 4, v11
    v_mul_u32_u24 v12, 768, v4
    v_lshl_add_u32 v12, v1, 4, v12
    v_and_b32 v14, 1, v2
    v_cmp_eq_u32 s[42:43], 1, v14
    v_readlane_b32 s8, v29, 0
    v_readlane_b32 s9, v29, 32
    s_nop 0
    v_mov_b32 v13, s8
    v_mov_b32 v14, s9
    v_cndmask_b32 v13, v13, v14, s[42:43]
    v_mfma_f32_16x16x32_bf16 v[240:243], v[40:43], v[104:107], 0
    v_mfma_f32_16x16x32_bf16 v[240:243], v[44:47], v[108:111], v[240:243]
    v_mfma_f32_16x16x32_bf16 v[240:243], v[48:51], v[112:115], v[240:243]
    v_mfma_f32_16x16x32_bf16 v[240:243], v[52:55], v[116:119], v[240:243]
    v_mfma_f32_16x16x32_bf16 v[240:243], v[56:59], v[120:123], v[240:243]
    v_mfma_f32_16x16x32_bf16 v[240:243], v[60:63], v[124:127], v[240:243]
    v_mfma_f32_16x16x32_bf16 v[240:243], v[64:67], v[128:131], v[240:243]
    v_mfma_f32_16x16x32_bf16 v[240:243], v[68:71], v[132:135], v[240:243]
    v_mfma_f32_16x16x32_bf16 v[240:243], v[72:75], v[136:139], v[240:243]
    v_mfma_f32_16x16x32_bf16 v[240:243], v[76:79], v[140:143], v[240:243]
    s_waitcnt vmcnt(13)
    s_cmp_lg_u32 s3, 0
    s_cbranch_scc1 L_sig_3
    s_mov_b64 exec, 1
    buffer_store_dword v238, v239, s[64:67], s60 offen
    s_mov_b64 exec, -1
L_sig_3:
    v_mfma_f32_16x16x32_bf16 v[240:243], v[80:83], v[144:147], v[240:243]
    s_waitcnt vmcnt(12)
    v_mfma_f32_16x16x32_bf16 v[240:243], v[84:87], v[148:151], v[240:243]
    s_waitcnt vmcnt(10)
    v_mfma_f32_16x16x32_bf16 v[240:243], v[88:91], v[152:155], v[240:243]
    s_waitcnt vmcnt(9)
    v_mfma_f32_16x16x32_bf16 v[240:243], v[92:95], v[156:159], v[240:243]
    s_waitcnt vmcnt(7)
    v_mfma_f32_16x16x32_bf16 v[240:243], v[96:99], v[160:163], v[240:243]
    s_waitcnt vmcnt(6)
    v_mfma_f32_16x16x32_bf16 v[240:243], v[100:103], v[164:167], v[240:243]
    s_nop 7
    ds_write_b128 v18, v[240:243]
    s_waitcnt lgkmcnt(0)
    s_barrier
    s_mov_b64 exec, s[62:63]
    ds_read_b128 v[240:243], v19 offset:0
    ds_read_b128 v[244:247], v19 offset:1024
    ds_read_b128 v[248:251], v19 offset:2048
    ds_read_b128 v[252:255], v19 offset:3072
    s_waitcnt lgkmcnt(2)
    v_pk_add_f32 v[240:241], v[240:241], v[244:245]
    v_pk_add_f32 v[242:243], v[242:243], v[246:247]
    s_waitcnt lgkmcnt(0)
    v_pk_add_f32 v[248:249], v[248:249], v[252:253]
    v_pk_add_f32 v[250:251], v[250:251], v[254:255]
    v_pk_add_f32 v[240:241], v[240:241], v[248:249]
    v_pk_add_f32 v[242:243], v[242:243], v[250:251]
    v_bfi_b32 v240, s77, v30, v240
    v_bfi_b32 v241, s77, v30, v241
    v_bfi_b32 v242, s77, v30, v242
    v_bfi_b32 v243, s77, v30, v243
    buffer_store_dwordx4 v[240:243], v28, s[64:67], s13 offen
    s_cmp_lg_u32 s61, 0
    s_cbranch_scc1 L_pub_4
    buffer_store_dwordx4 v[240:243], v28, s[64:67], s13 offen sc1
L_pub_4:
    s_mov_b64 exec, -1
    s_cmp_ge_u32 s10, 12
    s_cbranch_scc1 L_E_D
    buffer_load_dwordx4 v[232:235], v25, s[64:67], s86 offen sc1
    buffer_load_dword v64, v26, s[64:67], s83 offen offset:0 sc1
    buffer_load_dword v65, v26, s[64:67], s83 offen offset:512 sc1
    buffer_load_dword v66, v26, s[64:67], s83 offen offset:1024 sc1
    buffer_load_dword v67, v26, s[64:67], s83 offen offset:1536 sc1
    buffer_load_dword v68, v26, s[64:67], s83 offen offset:2048 sc1
    buffer_load_dword v69, v26, s[64:67], s83 offen offset:2560 sc1
    buffer_load_dword v70, v26, s[64:67], s83 offen offset:3072 sc1
    buffer_load_dword v71, v26, s[64:67], s83 offen offset:3584 sc1
    v_swap_b32 v170, v172
    v_swap_b32 v171, v173
    v_swap_b32 v178, v180
    v_swap_b32 v179, v181
    v_swap_b32 v186, v188
    v_swap_b32 v187, v189
    v_swap_b32 v194, v196
    v_swap_b32 v195, v197
    v_swap_b32 v202, v204
    v_swap_b32 v203, v205
    v_swap_b32 v210, v212
    v_swap_b32 v211, v213
    s_waitcnt vmcnt(8)
    s_branch L_gc_5
L_gr_7:
    buffer_load_dwordx4 v[232:235], v25, s[64:67], s86 offen sc1
    s_waitcnt vmcnt(0)
L_gc_5:
    v_xor_b32 v232, v30, v232
    v_xor_b32 v233, v30, v233
    v_xor_b32 v234, v30, v234
    v_xor_b32 v235, v30, v235
    v_or_b32 v76, v232, v233
    v_or3_b32 v76, v76, v234, v235
    v_and_b32 v76, s77, v76
    v_cmp_ne_u32 vcc, 0, v76
    s_cbranch_vccz L_gd_6
    s_add_u32 s79, s79, 1
    s_cmp_lt_u32 s79, 4000000
    s_cbranch_scc1 L_gr_7
L_gd_6:
    s_bitcmp1_b32 s11, 0
    s_cselect_b64 vcc, -1, 0
    v_cndmask_b32 v72, v232, v234, vcc
    v_cndmask_b32 v73, v233, v235, vcc
    v_mov_b32 v74, v72
    s_nop 1
    v_max_f32_dpp v74, v74, v74 quad_perm:[1,0,3,2] row_mask:0xf bank_mask:0xf
    s_nop 1
    v_max_f32_dpp v74, v74, v74 quad_perm:[2,3,0,1] row_mask:0xf bank_mask:0xf
    s_nop 1
    v_max_f32_dpp v74, v74, v74 row_half_mirror row_mask:0xf bank_mask:0xf
    v_sub_f32 v72, v72, v74
    v_mul_f32 v72, 0x3fb8aa3b, v72
    v_exp_f32 v72, v72
    s_nop 0
    v_mul_f32 v73, v73, v72
    s_nop 1
    v_add_f32_dpp v73, v73, v73 quad_perm:[1,0,3,2] row_mask:0xf bank_mask:0xf
    s_nop 1
    v_add_f32_dpp v73, v73, v73 quad_perm:[2,3,0,1] row_mask:0xf bank_mask:0xf
    s_nop 1
    v_add_f32_dpp v73, v73, v73 row_half_mirror row_mask:0xf bank_mask:0xf
    v_rcp_f32 v73, v73
    s_nop 0
    v_mul_f32 v72, v72, v73
    ds_write_b32 v6, v72
    s_waitcnt lgkmcnt(0)
    ds_read_b128 v[88:91], v7
    ds_read_b128 v[92:95], v7 offset:16
    s_waitcnt lgkmcnt(0)
    s_branch L_pc_8
L_pr_10:
    buffer_load_dword v64, v26, s[64:67], s83 offen offset:0 sc1
    buffer_load_dword v65, v26, s[64:67], s83 offen offset:512 sc1
    buffer_load_dword v66, v26, s[64:67], s83 offen offset:1024 sc1
    buffer_load_dword v67, v26, s[64:67], s83 offen offset:1536 sc1
    buffer_load_dword v68, v26, s[64:67], s83 offen offset:2048 sc1
    buffer_load_dword v69, v26, s[64:67], s83 offen offset:2560 sc1
    buffer_load_dword v70, v26, s[64:67], s83 offen offset:3072 sc1
    buffer_load_dword v71, v26, s[64:67], s83 offen offset:3584 sc1
L_pc_8:
    s_waitcnt vmcnt(7)
    v_xor_b32 v64, v30, v64
    v_mov_b32 v76, v64
    v_mul_f32 v100, v64, v88
    s_waitcnt vmcnt(6)
    v_xor_b32 v65, v30, v65
    v_or_b32 v76, v76, v65
    v_fmac_f32 v100, v65, v89
    s_waitcnt vmcnt(5)
    v_xor_b32 v66, v30, v66
    v_or_b32 v76, v76, v66
    v_fmac_f32 v100, v66, v90
    s_waitcnt vmcnt(4)
    v_xor_b32 v67, v30, v67
    v_or_b32 v76, v76, v67
    v_fmac_f32 v100, v67, v91
    s_waitcnt vmcnt(3)
    v_xor_b32 v68, v30, v68
    v_or_b32 v76, v76, v68
    v_fmac_f32 v100, v68, v92
    s_waitcnt vmcnt(2)
    v_xor_b32 v69, v30, v69
    v_or_b32 v76, v76, v69
    v_fmac_f32 v100, v69, v93
    s_waitcnt vmcnt(1)
    v_xor_b32 v70, v30, v70
    v_or_b32 v76, v76, v70
    v_fmac_f32 v100, v70, v94
    s_waitcnt vmcnt(0)
    v_xor_b32 v71, v30, v71
    v_or_b32 v76, v76, v71
    v_fmac_f32 v100, v71, v95
    v_and_b32 v76, s77, v76
    v_cmp_ne_u32 vcc, 0, v76
    s_cbranch_vccz L_pd_9
    s_add_u32 s79, s79, 1
    s_cmp_lt_u32 s79, 4000000
    s_cbranch_scc1 L_pr_10
L_pd_9:
    v_cvt_pk_bf16_f32 v100, v100, v100
    ds_bpermute_b32 v96, v21, v100 offset:0
    ds_bpermute_b32 v97, v21, v100 offset:4
    ds_bpermute_b32 v98, v21, v100 offset:64
    ds_bpermute_b32 v99, v21, v100 offset:68
    s_waitcnt lgkmcnt(2)
    v_and_b32 v84, v96, v36
    v_and_b32 v85, v96, v37
    v_and_b32 v86, v97, v36
    v_and_b32 v87, v97, v37
    s_waitcnt lgkmcnt(0)
    v_and_b32 v88, v98, v36
    v_and_b32 v89, v98, v37
    v_and_b32 v90, v99, v36
    v_and_b32 v91, v99, v37
    v_mfma_f32_16x16x32_bf16 v[240:243], v[84:87], v[168:171], 0
    s_nop 0
    v_mfma_f32_16x16x32_bf16 v[240:243], v[88:91], v[192:195], v[240:243]
    v_mfma_f32_16x16x32_bf16 v[244:247], v[84:87], v[172:175], 0
    v_mfma_f32_16x16x32_bf16 v[244:247], v[88:91], v[196:199], v[244:247]
    v_mfma_f32_16x16x32_bf16 v[248:251], v[84:87], v[176:179], 0
    v_mfma_f32_16x16x32_bf16 v[248:251], v[88:91], v[200:203], v[248:251]
    s_nop 3
    ds_write_b128 v22, v[240:243] offset:0
    v_mfma_f32_16x16x32_bf16 v[252:255], v[84:87], v[180:183], 0
    v_mfma_f32_16x16x32_bf16 v[252:255], v[88:91], v[204:207], v[252:255]
    ds_write_b128 v22, v[244:247] offset:16
    v_mfma_f32_16x16x32_bf16 v[76:79], v[84:87], v[184:187], 0
    v_mfma_f32_16x16x32_bf16 v[76:79], v[88:91], v[208:211], v[76:79]
    ds_write_b128 v22, v[248:251] offset:256
    v_mfma_f32_16x16x32_bf16 v[80:83], v[84:87], v[188:191], 0
    v_mfma_f32_16x16x32_bf16 v[80:83], v[88:91], v[212:215], v[80:83]
    s_nop 1
    ds_write_b128 v22, v[252:255] offset:272
    s_nop 1
    ds_write_b128 v22, v[76:79] offset:512
    s_nop 1
    ds_write_b128 v22, v[80:83] offset:528
    s_mov_b64 exec, 0xffffff
    s_waitcnt lgkmcnt(0)
    s_barrier
    ds_read_b128 v[40:43], v23 offset:0
    ds_read_b128 v[44:47], v23 offset:1536
    ds_read_b128 v[48:51], v23 offset:3072
    ds_read_b128 v[52:55], v23 offset:4608
    ds_read_b128 v[56:59], v23 offset:6144
    ds_read_b128 v[60:63], v23 offset:7680
    ds_read_b128 v[64:67], v23 offset:9216
    ds_read_b128 v[68:71], v23 offset:10752
    s_waitcnt lgkmcnt(6)
    v_pk_add_f32 v[40:41], v[40:41], v[44:45]
    v_pk_add_f32 v[42:43], v[42:43], v[46:47]
    s_waitcnt lgkmcnt(4)
    v_pk_add_f32 v[48:49], v[48:49], v[52:53]
    v_pk_add_f32 v[50:51], v[50:51], v[54:55]
    v_pk_add_f32 v[40:41], v[40:41], v[48:49]
    v_pk_add_f32 v[42:43], v[42:43], v[50:51]
    s_waitcnt lgkmcnt(2)
    v_pk_add_f32 v[56:57], v[56:57], v[60:61]
    v_pk_add_f32 v[58:59], v[58:59], v[62:63]
    s_waitcnt lgkmcnt(0)
    v_pk_add_f32 v[64:65], v[64:65], v[68:69]
    v_pk_add_f32 v[66:67], v[66:67], v[70:71]
    v_pk_add_f32 v[56:57], v[56:57], v[64:65]
    v_pk_add_f32 v[58:59], v[58:59], v[66:67]
    v_pk_add_f32 v[40:41], v[40:41], v[56:57]
    v_pk_add_f32 v[42:43], v[42:43], v[58:59]
    v_bfi_b32 v40, s77, v30, v40
    v_bfi_b32 v41, s77, v30, v41
    v_bfi_b32 v42, s77, v30, v42
    v_bfi_b32 v43, s77, v30, v43
    buffer_store_dwordx4 v[40:43], v39, s[64:67], s85 offen sc1
    s_mov_b64 exec, -1
    s_cmp_lt_u32 s10, 5
    s_cbranch_scc1 L_fin
    s_branch L_D2
L_E_D:
L_D2:
    buffer_load_dwordx4 v[128:131], v236, s[44:47], s51 offen offset:0 nt
    buffer_load_dwordx4 v[132:135], v236, s[44:47], s51 offen offset:1152 nt
    buffer_load_dwordx4 v[136:139], v236, s[44:47], s51 offen offset:128 nt
    buffer_load_dwordx4 v[140:143], v236, s[44:47], s51 offen offset:1280 nt
    buffer_load_dwordx4 v[144:147], v236, s[44:47], s51 offen offset:256 nt
    buffer_load_dwordx4 v[148:151], v236, s[44:47], s51 offen offset:1408 nt
    buffer_load_dwordx4 v[152:155], v236, s[44:47], s84 offen offset:0 nt
    buffer_load_dwordx4 v[156:159], v236, s[44:47], s84 offen offset:1152 nt
    buffer_load_dwordx4 v[160:163], v236, s[44:47], s84 offen offset:128 nt
    buffer_load_dwordx4 v[164:167], v236, s[44:47], s84 offen offset:1280 nt
    buffer_load_dwordx4 v[168:171], v236, s[44:47], s84 offen offset:256 nt
    buffer_load_dwordx4 v[172:175], v236, s[44:47], s84 offen offset:1408 nt
    s_waitcnt vmcnt(12)
    v_add_u32 v14, s100, v39
    ds_read2_b64 v[104:107], v14 offset0:0 offset1:128
    ds_read2_b64 v[108:111], v14 offset0:1 offset1:129
    v_add_u32 v14, 2048, v14
    ds_read2_b64 v[112:115], v14 offset0:0 offset1:128
    ds_read2_b64 v[116:119], v14 offset0:1 offset1:129
    v_add_u32 v14, 2048, v14
    ds_read2_b64 v[120:123], v14 offset0:0 offset1:128
    ds_read2_b64 v[124:127], v14 offset0:1 offset1:129
    v_mov_b32 v224, 0
    v_mov_b32 v225, 0
    v_mov_b32 v226, 0
    v_mov_b32 v227, 0
    s_waitcnt vmcnt(3)
    s_mov_b32 exec_lo, 268374015
    s_mov_b32 exec_hi, 268374015
    buffer_load_dwordx4 v[176:179], v12, s[64:67], s88 offen offset:0 sc1
    buffer_load_dwordx4 v[180:183], v12, s[64:67], s88 offen offset:1536 sc1
    buffer_load_dwordx4 v[184:187], v12, s[64:67], s88 offen offset:3072 sc1
    buffer_load_dwordx4 v[188:191], v12, s[64:67], s89 offen offset:0 sc1
    buffer_load_dwordx4 v[192:195], v12, s[64:67], s89 offen offset:1536 sc1
    buffer_load_dwordx4 v[196:199], v12, s[64:67], s89 offen offset:3072 sc1
    s_mov_b64 exec, -1
    s_mov_b32 exec_lo, 1061109567
    s_mov_b32 exec_hi, 1061109567
    buffer_load_dwordx4 v[224:227], v10, s[64:67], s41 offen sc1
    s_mov_b32 exec_lo, 268374015
    s_mov_b32 exec_hi, 268374015
    buffer_load_dwordx4 v[200:203], v11, s[64:67], s56 offen offset:0 sc1
    buffer_load_dwordx4 v[204:207], v11, s[64:67], s56 offen offset:3072 sc1
    buffer_load_dwordx4 v[208:211], v11, s[64:67], s57 offen offset:0 sc1
    buffer_load_dwordx4 v[212:215], v11, s[64:67], s57 offen offset:3072 sc1
    buffer_load_dwordx4 v[216:219], v11, s[64:67], s58 offen offset:0 sc1
    buffer_load_dwordx4 v[220:223], v11, s[64:67], s58 offen offset:3072 sc1
    s_mov_b64 exec, -1
    s_barrier
    s_waitcnt vmcnt(13)
    v_swap_b32 v130, v132
    v_swap_b32 v131, v133
    v_swap_b32 v138, v140
    v_swap_b32 v139, v141
    v_swap_b32 v146, v148
    v_swap_b32 v147, v149
    v_swap_b32 v154, v156
    v_swap_b32 v155, v157
    v_swap_b32 v162, v164
    v_swap_b32 v163, v165
    v_swap_b32 v170, v172
    v_swap_b32 v171, v173
    s_waitcnt vmcnt(7)
    s_branch L_gc_11
L_gr_13:
    s_mov_b32 exec_lo, 268374015
    s_mov_b32 exec_hi, 268374015
    buffer_load_dwordx4 v[176:179], v12, s[64:67], s88 offen offset:0 sc1
    buffer_load_dwordx4 v[180:183], v12, s[64:67], s88 offen offset:1536 sc1
    buffer_load_dwordx4 v[184:187], v12, s[64:67], s88 offen offset:3072 sc1
    buffer_load_dwordx4 v[188:191], v12, s[64:67], s89 offen offset:0 sc1
    buffer_load_dwordx4 v[192:195], v12, s[64:67], s89 offen offset:1536 sc1
    buffer_load_dwordx4 v[196:199], v12, s[64:67], s89 offen offset:3072 sc1
    s_mov_b64 exec, -1
    s_waitcnt vmcnt(0)
L_gc_11:
    v_mov_b32 v76, 0
    s_mov_b32 exec_lo, 268374015
    s_mov_b32 exec_hi, 268374015
    v_xor_b32 v176, v30, v176
    v_xor_b32 v177, v30, v177
    v_xor_b32 v178, v30, v178
    v_xor_b32 v179, v30, v179
    v_xor_b32 v180, v30, v180
    v_xor_b32 v181, v30, v181
    v_xor_b32 v182, v30, v182
    v_xor_b32 v183, v30, v183
    v_xor_b32 v184, v30, v184
    v_xor_b32 v185, v30, v185
    v_xor_b32 v186, v30, v186
    v_xor_b32 v187, v30, v187
    v_xor_b32 v188, v30, v188
    v_xor_b32 v189, v30, v189
    v_xor_b32 v190, v30, v190
    v_xor_b32 v191, v30, v191
    v_xor_b32 v192, v30, v192
    v_xor_b32 v193, v30, v193
    v_xor_b32 v194, v30, v194
    v_xor_b32 v195, v30, v195
    v_xor_b32 v196, v30, v196
    v_xor_b32 v197, v30, v197
    v_xor_b32 v198, v30, v198
    v_xor_b32 v199, v30, v199
    v_or_b32 v76, v176, v177
    v_or3_b32 v76, v76, v178, v179
    v_or3_b32 v76, v76, v180, v181
    v_or3_b32 v76, v76, v182, v183
    v_or3_b32 v76, v76, v184, v185
    v_or3_b32 v76, v76, v186, v187
    v_or3_b32 v76, v76, v188, v189
    v_or3_b32 v76, v76, v190, v191
    v_or3_b32 v76, v76, v192, v193
    v_or3_b32 v76, v76, v194, v195
    v_or3_b32 v76, v76, v196, v197
    v_or3_b32 v76, v76, v198, v199
    s_mov_b64 exec, -1
    v_and_b32 v76, s77, v76
    v_cmp_ne_u32 vcc, 0, v76
    s_cbranch_vccz L_gd_12
    s_add_u32 s79, s79, 1
    s_cmp_lt_u32 s79, 4000000
    s_cbranch_scc1 L_gr_13
L_gd_12:
    v_pk_add_f32 v[176:177], v[176:177], v[180:181]
    v_pk_add_f32 v[184:185], v[184:185], v[188:189]
    v_pk_add_f32 v[192:193], v[192:193], v[196:197]
    v_pk_add_f32 v[178:179], v[178:179], v[182:183]
    v_pk_add_f32 v[186:187], v[186:187], v[190:191]
    v_pk_add_f32 v[194:195], v[194:195], v[198:199]
    v_pk_add_f32 v[176:177], v[176:177], v[184:185]
    v_pk_add_f32 v[178:179], v[178:179], v[186:187]
    v_pk_add_f32 v[68:69], v[176:177], v[192:193]
    v_pk_add_f32 v[70:71], v[178:179], v[194:195]
    s_nop 1
    v_permlane32_swap_b32 v68, v70
    v_permlane32_swap_b32 v69, v71
    s_branch L_pc_14
L_pr_16:
    s_mov_b32 exec_lo, 1061109567
    s_mov_b32 exec_hi, 1061109567
    buffer_load_dwordx4 v[224:227], v10, s[64:67], s41 offen sc1
    s_mov_b32 exec_lo, 268374015
    s_mov_b32 exec_hi, 268374015
    buffer_load_dwordx4 v[200:203], v11, s[64:67], s56 offen offset:0 sc1
    buffer_load_dwordx4 v[204:207], v11, s[64:67], s56 offen offset:3072 sc1
    buffer_load_dwordx4 v[208:211], v11, s[64:67], s57 offen offset:0 sc1
    buffer_load_dwordx4 v[212:215], v11, s[64:67], s57 offen offset:3072 sc1
    buffer_load_dwordx4 v[216:219], v11, s[64:67], s58 offen offset:0 sc1
    buffer_load_dwordx4 v[220:223], v11, s[64:67], s58 offen offset:3072 sc1
    s_mov_b64 exec, -1
L_pc_14:
    v_mov_b32 v76, 0
    s_mov_b32 exec_lo, 1061109567
    s_mov_b32 exec_hi, 1061109567
    s_waitcnt vmcnt(6)
    v_xor_b32 v224, v30, v224
    v_xor_b32 v225, v30, v225
    v_xor_b32 v226, v30, v226
    v_xor_b32 v227, v30, v227
    v_or_b32 v76, v224, v225
    v_or3_b32 v76, v76, v226, v227
    s_mov_b64 exec, -1
    v_cndmask_b32 v72, v224, v226, s[42:43]
    v_cndmask_b32 v73, v225, v227, s[42:43]
    s_nop 0
    v_add_f32_dpp v72, v72, v72 row_ror:4 row_mask:0xf bank_mask:0xf
    v_add_f32_dpp v73, v73, v73 row_ror:4 row_mask:0xf bank_mask:0xf
    s_nop 0
    v_add_f32_dpp v72, v72, v72 row_ror:2 row_mask:0xf bank_mask:0xf
    v_add_f32_dpp v73, v73, v73 row_ror:2 row_mask:0xf bank_mask:0xf
    s_nop 0
    v_add_f32_dpp v72, v72, v72 row_ror:1 row_mask:0xf bank_mask:0xf
    v_add_f32_dpp v73, v73, v73 row_ror:1 row_mask:0xf bank_mask:0xf
    v_mul_f32 v72, 0x3ae38e39, v72
    v_mul_f32 v73, 0x3ae38e39, v73
    s_mov_b32 exec_lo, 268374015
    s_mov_b32 exec_hi, 268374015
    s_waitcnt vmcnt(5)
    v_xor_b32 v200, v30, v200
    v_xor_b32 v201, v30, v201
    v_xor_b32 v202, v30, v202
    v_xor_b32 v203, v30, v203
    v_or3_b32 v76, v76, v200, v201
    v_or3_b32 v76, v76, v202, v203
    s_waitcnt vmcnt(4)
    v_xor_b32 v204, v30, v204
    v_xor_b32 v205, v30, v205
    v_xor_b32 v206, v30, v206
    v_xor_b32 v207, v30, v207
    v_or3_b32 v76, v76, v204, v205
    v_or3_b32 v76, v76, v206, v207
    v_pk_add_f32 v[64:65], v[200:201], v[204:205]
    v_pk_add_f32 v[66:67], v[202:203], v[206:207]
    s_waitcnt vmcnt(3)
    v_xor_b32 v208, v30, v208
    v_xor_b32 v209, v30, v209
    v_xor_b32 v210, v30, v210
    v_xor_b32 v211, v30, v211
    v_or3_b32 v76, v76, v208, v209
    v_or3_b32 v76, v76, v210, v211
    v_pk_add_f32 v[64:65], v[64:65], v[208:209]
    v_pk_add_f32 v[66:67], v[66:67], v[210:211]
    s_waitcnt vmcnt(2)
    v_xor_b32 v212, v30, v212
    v_xor_b32 v213, v30, v213
    v_xor_b32 v214, v30, v214
    v_xor_b32 v215, v30, v215
    v_or3_b32 v76, v76, v212, v213
    v_or3_b32 v76, v76, v214, v215
    v_pk_add_f32 v[64:65], v[64:65], v[212:213]
    v_pk_add_f32 v[66:67], v[66:67], v[214:215]
    s_waitcnt vmcnt(1)
    v_xor_b32 v216, v30, v216
    v_xor_b32 v217, v30, v217
    v_xor_b32 v218, v30, v218
    v_xor_b32 v219, v30, v219
    v_or3_b32 v76, v76, v216, v217
    v_or3_b32 v76, v76, v218, v219
    v_pk_add_f32 v[64:65], v[64:65], v[216:217]
    v_pk_add_f32 v[66:67], v[66:67], v[218:219]
    s_waitcnt vmcnt(0)
    v_xor_b32 v220, v30, v220
    v_xor_b32 v221, v30, v221
    v_xor_b32 v222, v30, v222
    v_xor_b32 v223, v30, v223
    v_or3_b32 v76, v76, v220, v221
    v_or3_b32 v76, v76, v222, v223
    v_pk_add_f32 v[64:65], v[64:65], v[220:221]
    v_pk_add_f32 v[66:67], v[66:67], v[222:223]
    s_mov_b64 exec, -1
    v_and_b32 v76, s77, v76
    v_cmp_ne_u32 vcc, 0, v76
    s_cbranch_vccz L_pd_15
    s_add_u32 s79, s79, 1
    s_cmp_lt_u32 s79, 4000000
    s_cbranch_scc1 L_pr_16
L_pd_15:
    v_fma_f32 v73, -v72, v72, v73
    v_add_f32 v72, v72, v13
    v_max_f32 v73, 0, v73
    v_permlane32_swap_b32 v64, v66
    v_permlane32_swap_b32 v65, v67
    v_cvt_pk_bf16_f32 v74, v73, v72
    v_lshlrev_b32 v73, 16, v74
    v_and_b32 v72, 0xffff0000, v74
    v_add_f32 v73, 0x3727c5ac, v73
    v_cvt_pk_bf16_f32 v73, v73, v73
    v_and_b32 v73, 0xffff0000, v73
    v_sqrt_f32 v73, v73
    v_fma_f32 v64, -v72, v68, v64
    v_fma_f32 v65, -v72, v69, v65
    v_fma_f32 v66, -v72, v70, v66
    v_fma_f32 v67, -v72, v71, v67
    v_cvt_pk_bf16_f32 v73, v73, v73
    v_and_b32 v73, 0xffff0000, v73
    v_rcp_f32 v73, v73
    s_nop 0
    v_mul_f32 v64, v64, v73
    v_mul_f32 v65, v65, v73
    v_mul_f32 v66, v66, v73
    v_mul_f32 v67, v67, v73
    v_cvt_pk_bf16_f32 v68, v64, v65
    v_cvt_pk_bf16_f32 v69, v66, v67
    v_lshlrev_b32 v64, 16, v68
    v_and_b32 v65, 0xffff0000, v68
    v_lshlrev_b32 v66, 16, v69
    v_and_b32 v67, 0xffff0000, v69
    v_mul_f32 v68, 0xbfb8aa3b, v64
    v_mul_f32 v69, 0xbfb8aa3b, v65
    v_exp_f32 v68, v68
    v_exp_f32 v69, v69
    v_add_f32 v68, 1.0, v68
    v_add_f32 v69, 1.0, v69
    v_rcp_f32 v68, v68
    v_rcp_f32 v69, v69
    v_mul_f32 v64, v64, v68
    v_mul_f32 v65, v65, v69
    v_cvt_pk_bf16_f32 v68, v64, v65
    v_lshlrev_b32 v64, 16, v68
    v_and_b32 v65, 0xffff0000, v68
    v_mul_f32 v64, v64, v66
    v_mul_f32 v65, v65, v67
    v_cvt_pk_bf16_f32 v102, v64, v64
    v_cvt_pk_bf16_f32 v103, v65, v65
    ds_bpermute_b32 v96, v3, v102 offset:0
    ds_bpermute_b32 v97, v3, v103 offset:0
    ds_bpermute_b32 v98, v3, v102 offset:16
    ds_bpermute_b32 v99, v3, v103 offset:16
    ds_bpermute_b32 v100, v3, v102 offset:32
    ds_bpermute_b32 v101, v3, v103 offset:32
    s_waitcnt lgkmcnt(4)
    v_and_b32 v84, v96, v36
    v_and_b32 v85, v96, v37
    v_and_b32 v86, v97, v36
    v_and_b32 v87, v97, v37
    s_waitcnt lgkmcnt(2)
    v_and_b32 v88, v98, v36
    v_and_b32 v89, v98, v37
    v_and_b32 v90, v99, v36
    v_and_b32 v91, v99, v37
    s_waitcnt lgkmcnt(0)
    v_and_b32 v92, v100, v36
    v_and_b32 v93, v100, v37
    v_and_b32 v94, v101, v36
    v_and_b32 v95, v101, v37
    v_mfma_f32_16x16x32_bf16 v[240:243], v[84:87], v[104:107], 0
    v_mfma_f32_16x16x32_bf16 v[240:243], v[88:91], v[128:131], v[240:243]
    v_mfma_f32_16x16x32_bf16 v[240:243], v[92:95], v[152:155], v[240:243]
    v_mfma_f32_16x16x32_bf16 v[244:247], v[84:87], v[108:111], 0
    v_mfma_f32_16x16x32_bf16 v[244:247], v[88:91], v[132:135], v[244:247]
    v_mfma_f32_16x16x32_bf16 v[244:247], v[92:95], v[156:159], v[244:247]
    v_mfma_f32_16x16x32_bf16 v[248:251], v[84:87], v[112:115], 0
    v_mfma_f32_16x16x32_bf16 v[248:251], v[88:91], v[136:139], v[248:251]
    v_mfma_f32_16x16x32_bf16 v[248:251], v[92:95], v[160:163], v[248:251]
    s_nop 1
    ds_write_b128 v22, v[240:243] offset:0
    v_mfma_f32_16x16x32_bf16 v[252:255], v[84:87], v[116:119], 0
    v_mfma_f32_16x16x32_bf16 v[252:255], v[88:91], v[140:143], v[252:255]
    v_mfma_f32_16x16x32_bf16 v[252:255], v[92:95], v[164:167], v[252:255]
    ds_write_b128 v22, v[244:247] offset:16
    v_mfma_f32_16x16x32_bf16 v[76:79], v[84:87], v[120:123], 0
    v_mfma_f32_16x16x32_bf16 v[76:79], v[88:91], v[144:147], v[76:79]
    v_mfma_f32_16x16x32_bf16 v[76:79], v[92:95], v[168:171], v[76:79]
    ds_write_b128 v22, v[248:251] offset:256
    v_mfma_f32_16x16x32_bf16 v[80:83], v[84:87], v[124:127], 0
    v_mfma_f32_16x16x32_bf16 v[80:83], v[88:91], v[148:151], v[80:83]
    v_mfma_f32_16x16x32_bf16 v[80:83], v[92:95], v[172:175], v[80:83]
    ds_write_b128 v22, v[252:255] offset:272
    s_nop 2
    ds_write_b128 v22, v[76:79] offset:512
    s_nop 2
    ds_write_b128 v22, v[80:83] offset:528
    s_mov_b64 exec, 0xffffff
    s_waitcnt lgkmcnt(0)
    s_barrier
    ds_read_b128 v[40:43], v23 offset:0
    ds_read_b128 v[44:47], v23 offset:1536
    ds_read_b128 v[48:51], v23 offset:3072
    ds_read_b128 v[52:55], v23 offset:4608
    ds_read_b128 v[56:59], v23 offset:6144
    ds_read_b128 v[60:63], v23 offset:7680
    ds_read_b128 v[64:67], v23 offset:9216
    ds_read_b128 v[68:71], v23 offset:10752
    s_waitcnt lgkmcnt(6)
    v_pk_add_f32 v[40:41], v[40:41], v[44:45]
    v_pk_add_f32 v[42:43], v[42:43], v[46:47]
    s_waitcnt lgkmcnt(4)
    v_pk_add_f32 v[48:49], v[48:49], v[52:53]
    v_pk_add_f32 v[50:51], v[50:51], v[54:55]
    v_pk_add_f32 v[40:41], v[40:41], v[48:49]
    v_pk_add_f32 v[42:43], v[42:43], v[50:51]
    s_waitcnt lgkmcnt(2)
    v_pk_add_f32 v[56:57], v[56:57], v[60:61]
    v_pk_add_f32 v[58:59], v[58:59], v[62:63]
    s_waitcnt lgkmcnt(0)
    v_pk_add_f32 v[64:65], v[64:65], v[68:69]
    v_pk_add_f32 v[66:67], v[66:67], v[70:71]
    v_pk_add_f32 v[56:57], v[56:57], v[64:65]
    v_pk_add_f32 v[58:59], v[58:59], v[66:67]
    v_pk_add_f32 v[40:41], v[40:41], v[56:57]
    v_pk_add_f32 v[42:43], v[42:43], v[58:59]
    v_bfi_b32 v40, s77, v30, v40
    v_bfi_b32 v41, s77, v30, v41
    v_bfi_b32 v42, s77, v30, v42
    v_bfi_b32 v43, s77, v30, v43
    buffer_store_dwordx4 v[40:43], v39, s[64:67], s40 offen sc1
    s_mov_b64 exec, -1
    s_branch L_fin
L_F:
    s_mul_i32 s10, s5, 11
    s_lshr_b32 s10, s10, 5
    s_cmp_eq_u32 s5, 17
    s_cselect_b32 s10, 5, s10
    s_cmp_eq_u32 s5, 14
    s_cselect_b32 s10, 4, s10
    s_mul_i32 s8, s10, 3
    s_sub_u32 s11, s5, s8
    s_cmp_ge_u32 s3, 2
    s_cselect_b32 s56, s30, s28
    s_cselect_b32 s57, s31, s29
    s_and_b32 s57, s57, 0xffff
    s_mov_b32 s58, 5308416
    s_mov_b32 s59, 0x00020000
    v_lshrrev_b32 v20, 3, v1
    v_lshlrev_b32 v20, 3, v20
    v_lshl_add_u32 v20, v2, 1, v20
    v_mul_u32_u24 v20, 9216, v20
    v_and_b32 v14, 7, v1
    v_lshl_add_u32 v20, v14, 4, v20
    s_mul_i32 s12, s4, 3
    s_add_u32 s12, s12, s11
    s_mul_i32 s8, s10, 96
    s_and_b32 s9, s3, 1
    s_mul_i32 s9, s9, 48
    s_add_u32 s8, s8, s9
    s_mul_i32 s81, s8, 9216
    s_mul_i32 s9, s12, 384
    s_add_u32 s81, s81, s9
    v_mul_u32_u24 v21, 1152, v4
    v_lshl_add_u32 v21, v5, 3, v21
    s_mul_i32 s8, s10, 192
    buffer_load_dwordx2 v[26:27], v21, s[68:71], s8 offen
    s_lshl_b32 s80, s10, 18
    s_mul_i32 s82, s3, 6144
    s_add_u32 s82, s82, s80
    s_add_u32 s82, s82, 331776
    s_add_u32 s83, s82, 3072
    v_mul_u32_u24 v21, 384, v4
    v_lshl_add_u32 v21, v5, 4, v21
    s_mul_i32 s8, s3, 3072
    v_lshrrev_b32 v14, 3, v1
    v_mul_u32_u24 v22, 1536, v14
    v_and_b32 v14, 1, v2
    v_mul_u32_u24 v14, 768, v14
    v_add_u32 v22, v22, v14
    v_and_b32 v14, 7, v1
    v_lshl_add_u32 v22, v14, 5, v22
    v_add_u32 v22, s8, v22
    v_lshrrev_b32 v14, 3, v1
    v_lshrrev_b32 v15, 1, v2
    v_cmp_eq_u32 vcc, v14, v15
    v_add_u32 v14, 16384, v39
    s_nop 0
    v_cndmask_b32 v22, v14, v22, vcc
    s_lshl_b32 s8, s3, 10
    s_add_u32 s8, s8, 65536
    v_add_u32 v16, s8, v39
    s_lshr_b32 s8, s3, 1
    s_mul_i32 s8, s8, 6144
    s_and_b32 s9, s3, 1
    s_mul_i32 s9, s9, 768
    s_add_u32 s8, s8, s9
    v_add_u32 v23, s8, v39
    s_mul_i32 s84, s3, 768
    s_add_u32 s84, s84, 75392
    v_add_u32 v17, s84, v21
    v_bfe_u32 v14, v1, 2, 1
    v_mul_u32_u24 v24, 384, v14
    v_lshrrev_b32 v14, 3, v1
    v_lshl_add_u32 v24, v14, 5, v24
    v_lshl_add_u32 v24, v2, 3, v24
    s_and_b32 s9, s3, 1
    s_mul_i32 s9, s9, 192
    s_add_u32 s9, s9, s84
    v_add_u32 v24, s9, v24
    v_add_u32 v25, 78720, v21
    s_mul_i32 s8, s11, 6
    s_add_u32 s8, s8, s10
    s_mul_i32 s85, s8, 3072
    s_mul_i32 s9, s3, 768
    s_add_u32 s85, s85, s9
    s_add_u32 s85, s85, s99
    s_add_u32 s85, s85, 385024
    s_mul_i32 s87, s8, 1536
    s_lshr_b32 s9, s3, 1
    s_mul_i32 s9, s9, 768
    s_add_u32 s87, s87, s9
    s_add_u32 s87, s87, s99
    s_add_u32 s87, s87, 442368
    s_lshl_b32 s86, s11, 10
    s_lshl_b32 s9, s10, 7
    s_add_u32 s86, s86, s9
    s_add_u32 s86, s86, s99
    s_add_u32 s86, s86, 471040
    v_and_b32 v10, 0x3f803f80, v36
    v_and_b32 v11, 0x3f803f80, v37
    v_mov_b32 v12, v10
    v_mov_b32 v13, v11
    s_mov_b32 s72, s34
    s_and_b32 s73, s35, 0xffff
    s_mov_b32 s74, 2304
    s_mov_b32 s75, 0x00020000
    s_lshl_b32 s9, s12, 5
    s_add_u32 s40, s80, s9
    s_add_u32 s40, s40, 356352
    s_add_u32 s41, s40, 6144
    s_add_u32 s42, s40, 12288
    v_lshrrev_b32 v14, 3, v0
    v_mul_u32_u24 v7, 768, v14
    v_and_b32 v14, 7, v0
    v_lshl_add_u32 v7, v14, 2, v7
    s_add_u32 s8, s9, 78720
    v_lshlrev_b32 v8, 2, v14
    v_add_u32 v8, s8, v8
    s_cmp_ge_u32 s12, 12
    s_cselect_b32 s43, 480, 0
    s_mul_i32 s8, s10, 96
    s_add_u32 s43, s43, s8
    s_lshl_b32 s8, s12, 3
    s_add_u32 s43, s43, s8
    s_lshl_b32 s43, s43, 1
    v_lshlrev_b32 v3, 1, v14
    v_mfma_f32_16x16x32_bf16 v[240:243], v[40:43], v[104:107], 0
    v_mfma_f32_16x16x32_bf16 v[240:243], v[44:47], v[108:111], v[240:243]
    v_mfma_f32_16x16x32_bf16 v[240:243], v[48:51], v[112:115], v[240:243]
    v_mfma_f32_16x16x32_bf16 v[240:243], v[52:55], v[116:119], v[240:243]
    v_mfma_f32_16x16x32_bf16 v[240:243], v[56:59], v[120:123], v[240:243]
    v_mfma_f32_16x16x32_bf16 v[240:243], v[60:63], v[124:127], v[240:243]
    v_mfma_f32_16x16x32_bf16 v[240:243], v[64:67], v[128:131], v[240:243]
    v_mfma_f32_16x16x32_bf16 v[240:243], v[68:71], v[132:135], v[240:243]
    v_mfma_f32_16x16x32_bf16 v[240:243], v[72:75], v[136:139], v[240:243]
    v_mfma_f32_16x16x32_bf16 v[240:243], v[76:79], v[140:143], v[240:243]
    buffer_load_dwordx4 v[168:171], v20, s[56:59], s81 offen offset:0 nt
    s_waitcnt vmcnt(9)
    s_cmp_lg_u32 s3, 0
    s_cbranch_scc1 L_sig_17
    s_mov_b64 exec, 1
    buffer_store_dword v238, v239, s[64:67], s60 offen
    s_mov_b64 exec, -1
L_sig_17:
    v_mfma_f32_16x16x32_bf16 v[240:243], v[80:83], v[144:147], v[240:243]
    buffer_load_dwordx4 v[176:179], v20, s[56:59], s81 offen offset:128 nt
    s_waitcnt vmcnt(9)
    v_mfma_f32_16x16x32_bf16 v[240:243], v[84:87], v[148:151], v[240:243]
    buffer_load_dwordx4 v[184:187], v20, s[56:59], s81 offen offset:256 nt
    s_add_u32 s81, s81, 9216
    s_waitcnt vmcnt(8)
    v_mfma_f32_16x16x32_bf16 v[240:243], v[88:91], v[152:155], v[240:243]
    buffer_load_dwordx4 v[172:175], v20, s[56:59], s81 offen offset:0 nt
    s_waitcnt vmcnt(8)
    v_mfma_f32_16x16x32_bf16 v[240:243], v[92:95], v[156:159], v[240:243]
    buffer_load_dwordx4 v[180:183], v20, s[56:59], s81 offen offset:128 nt
    s_waitcnt vmcnt(7)
    v_mfma_f32_16x16x32_bf16 v[240:243], v[96:99], v[160:163], v[240:243]
    buffer_load_dwordx4 v[188:191], v20, s[56:59], s81 offen offset:256 nt
    s_add_u32 s81, s81, 138240
    s_waitcnt vmcnt(7)
    v_mfma_f32_16x16x32_bf16 v[240:243], v[100:103], v[164:167], v[240:243]
    s_nop 7
    ds_write_b128 v18, v[240:243]
    s_waitcnt lgkmcnt(0)
    s_barrier
    s_mov_b64 exec, s[62:63]
    ds_read_b128 v[240:243], v19 offset:0
    ds_read_b128 v[244:247], v19 offset:1024
    ds_read_b128 v[248:251], v19 offset:2048
    ds_read_b128 v[252:255], v19 offset:3072
    s_waitcnt lgkmcnt(2)
    v_pk_add_f32 v[240:241], v[240:241], v[244:245]
    v_pk_add_f32 v[242:243], v[242:243], v[246:247]
    s_waitcnt lgkmcnt(0)
    v_pk_add_f32 v[248:249], v[248:249], v[252:253]
    v_pk_add_f32 v[250:251], v[250:251], v[254:255]
    v_pk_add_f32 v[240:241], v[240:241], v[248:249]
    v_pk_add_f32 v[242:243], v[242:243], v[250:251]
    v_bfi_b32 v240, s77, v30, v240
    v_bfi_b32 v241, s77, v30, v241
    v_bfi_b32 v242, s77, v30, v242
    v_bfi_b32 v243, s77, v30, v243
    buffer_store_dwordx4 v[240:243], v28, s[64:67], s13 offen
    s_cmp_lg_u32 s61, 0
    s_cbranch_scc1 L_pub_18
    buffer_store_dwordx4 v[240:243], v28, s[64:67], s13 offen sc1
L_pub_18:
    s_mov_b64 exec, -1
    s_cmp_eq_u32 s61, 0
    s_cbranch_scc1 L_gate_done
    v_lshlrev_b32 v14, 2, v5
    s_mov_b32 s8, 0
L_gate:
    buffer_load_dword v15, v14, s[64:67], s60 offen sc1
    s_waitcnt vmcnt(0)
    v_cmp_ne_u32 vcc, s78, v15
    s_cbranch_vccz L_gate_done
    s_add_u32 s8, s8, 1
    s_cmp_lt_u32 s8, 256
    s_cbranch_scc1 L_gate
L_gate_done:
    buffer_load_dwordx4 v[192:195], v20, s[56:59], s81 offen offset:0 nt
    buffer_load_dwordx4 v[200:203], v20, s[56:59], s81 offen offset:128 nt
    buffer_load_dwordx4 v[208:211], v20, s[56:59], s81 offen offset:256 nt
    s_add_u32 s81, s81, 9216
    buffer_load_dwordx4 v[196:199], v20, s[56:59], s81 offen offset:0 nt
    buffer_load_dwordx4 v[204:207], v20, s[56:59], s81 offen offset:128 nt
    buffer_load_dwordx4 v[212:215], v20, s[56:59], s81 offen offset:256 nt
    s_add_u32 s81, s81, 138240
    buffer_load_dwordx4 v[216:219], v20, s[56:59], s81 offen offset:0 nt
    buffer_load_dwordx4 v[224:227], v20, s[56:59], s81 offen offset:128 nt
    buffer_load_dwordx4 v[232:235], v20, s[56:59], s81 offen offset:256 nt
    s_add_u32 s81, s81, 9216
    buffer_load_dwordx4 v[220:223], v20, s[56:59], s81 offen offset:0 nt
    s_waitcnt vmcnt(17)
    buffer_load_dwordx4 v[228:231], v20, s[56:59], s81 offen offset:128 nt
    s_waitcnt vmcnt(17)
    buffer_load_dwordx4 v[236:239], v20, s[56:59], s81 offen offset:256 nt
    s_add_u32 s81, s81, 138240
    v_lshlrev_b32 v100, 16, v26
    v_and_b32 v101, 0xffff0000, v26
    v_lshlrev_b32 v102, 16, v27
    v_and_b32 v103, 0xffff0000, v27
    s_waitcnt vmcnt(15)
    v_swap_b32 v170, v172
    v_swap_b32 v171, v173
    s_nop 1
    v_mfma_f32_16x16x32_bf16 v[40:43], v[10:13], v[168:171], 0
    v_mfma_f32_16x16x32_bf16 v[44:47], v[10:13], v[172:175], 0
    s_waitcnt vmcnt(14)
    v_swap_b32 v178, v180
    v_swap_b32 v179, v181
    s_nop 1
    v_mfma_f32_16x16x32_bf16 v[48:51], v[10:13], v[176:179], 0
    v_mfma_f32_16x16x32_bf16 v[52:55], v[10:13], v[180:183], 0
    s_waitcnt vmcnt(13)
    v_swap_b32 v186, v188
    v_swap_b32 v187, v189
    s_nop 1
    v_mfma_f32_16x16x32_bf16 v[56:59], v[10:13], v[184:187], 0
    v_mfma_f32_16x16x32_bf16 v[60:63], v[10:13], v[188:191], 0
    s_waitcnt vmcnt(8)
    v_swap_b32 v194, v196
    v_swap_b32 v195, v197
    s_nop 1
    v_mfma_f32_16x16x32_bf16 v[40:43], v[10:13], v[192:195], v[40:43]
    v_mfma_f32_16x16x32_bf16 v[44:47], v[10:13], v[196:199], v[44:47]
    s_waitcnt vmcnt(7)
    v_swap_b32 v202, v204
    v_swap_b32 v203, v205
    s_nop 1
    v_mfma_f32_16x16x32_bf16 v[48:51], v[10:13], v[200:203], v[48:51]
    v_mfma_f32_16x16x32_bf16 v[52:55], v[10:13], v[204:207], v[52:55]
    s_waitcnt vmcnt(6)
    v_swap_b32 v210, v212
    v_swap_b32 v211, v213
    s_nop 1
    v_mfma_f32_16x16x32_bf16 v[56:59], v[10:13], v[208:211], v[56:59]
    v_mfma_f32_16x16x32_bf16 v[60:63], v[10:13], v[212:215], v[60:63]
    s_waitcnt vmcnt(2)
    v_swap_b32 v218, v220
    v_swap_b32 v219, v221
    s_nop 1
    v_mfma_f32_16x16x32_bf16 v[40:43], v[10:13], v[216:219], v[40:43]
    v_mfma_f32_16x16x32_bf16 v[44:47], v[10:13], v[220:223], v[44:47]
    s_waitcnt vmcnt(1)
    v_swap_b32 v226, v228
    v_swap_b32 v227, v229
    s_nop 1
    v_mfma_f32_16x16x32_bf16 v[48:51], v[10:13], v[224:227], v[48:51]
    v_mfma_f32_16x16x32_bf16 v[52:55], v[10:13], v[228:231], v[52:55]
    s_waitcnt vmcnt(0)
    v_swap_b32 v234, v236
    v_swap_b32 v235, v237
    s_nop 1
    v_mfma_f32_16x16x32_bf16 v[56:59], v[10:13], v[232:235], v[56:59]
    v_mfma_f32_16x16x32_bf16 v[60:63], v[10:13], v[236:239], v[60:63]
    s_mov_b32 exec_lo, 16777215
    s_mov_b32 exec_hi, 16777215
    buffer_load_dwordx4 v[104:107], v21, s[64:67], s82 offen offset:0 sc1
    buffer_load_dwordx4 v[108:111], v21, s[64:67], s82 offen offset:768 sc1
    buffer_load_dwordx4 v[112:115], v21, s[64:67], s82 offen offset:1536 sc1
    buffer_load_dwordx4 v[116:119], v21, s[64:67], s82 offen offset:2304 sc1
    buffer_load_dwordx4 v[120:123], v21, s[64:67], s83 offen offset:0 sc1
    buffer_load_dwordx4 v[124:127], v21, s[64:67], s83 offen offset:768 sc1
    buffer_load_dwordx4 v[128:131], v21, s[64:67], s83 offen offset:1536 sc1
    buffer_load_dwordx4 v[132:135], v21, s[64:67], s83 offen offset:2304 sc1
    s_mov_b64 exec, -1
    ds_write_b128 v22, v[40:43] offset:0
    ds_write_b128 v22, v[44:47] offset:16
    ds_write_b128 v22, v[48:51] offset:256
    ds_write_b128 v22, v[52:55] offset:272
    ds_write_b128 v22, v[56:59] offset:512
    ds_write_b128 v22, v[60:63] offset:528
    s_waitcnt lgkmcnt(0)
    s_barrier
    s_bitcmp1_b32 s3, 0
    s_cbranch_scc1 L_noS
    s_mov_b32 exec_lo, -1
    s_mov_b32 exec_hi, 0xffff
    ds_read_b128 v[136:139], v23 offset:0
    ds_read_b128 v[140:143], v23 offset:1536
    ds_read_b128 v[144:147], v23 offset:3072
    ds_read_b128 v[148:151], v23 offset:4608
    s_waitcnt lgkmcnt(2)
    v_pk_add_f32 v[136:137], v[136:137], v[140:141]
    v_pk_add_f32 v[138:139], v[138:139], v[142:143]
    s_waitcnt lgkmcnt(0)
    v_pk_add_f32 v[144:145], v[144:145], v[148:149]
    v_pk_add_f32 v[146:147], v[146:147], v[150:151]
    v_pk_add_f32 v[136:137], v[136:137], v[144:145]
    v_pk_add_f32 v[138:139], v[138:139], v[146:147]
    v_bfi_b32 v136, s77, v30, v136
    v_bfi_b32 v137, s77, v30, v137
    v_bfi_b32 v138, s77, v30, v138
    v_bfi_b32 v139, s77, v30, v139
    buffer_store_dwordx4 v[136:139], v39, s[64:67], s87 offen
    s_cmp_lg_u32 s61, 0
    s_cbranch_scc1 L_pub_19
    buffer_store_dwordx4 v[136:139], v39, s[64:67], s87 offen sc1
L_pub_19:
    s_mov_b64 exec, -1
L_noS:
L_S1:
    s_branch L_pc_20
L_pr_22:
    s_mov_b32 exec_lo, 16777215
    s_mov_b32 exec_hi, 16777215
    buffer_load_dwordx4 v[104:107], v21, s[64:67], s82 offen offset:0 sc1
    buffer_load_dwordx4 v[108:111], v21, s[64:67], s82 offen offset:768 sc1
    buffer_load_dwordx4 v[112:115], v21, s[64:67], s82 offen offset:1536 sc1
    buffer_load_dwordx4 v[116:119], v21, s[64:67], s82 offen offset:2304 sc1
    buffer_load_dwordx4 v[120:123], v21, s[64:67], s83 offen offset:0 sc1
    buffer_load_dwordx4 v[124:127], v21, s[64:67], s83 offen offset:768 sc1
    buffer_load_dwordx4 v[128:131], v21, s[64:67], s83 offen offset:1536 sc1
    buffer_load_dwordx4 v[132:135], v21, s[64:67], s83 offen offset:2304 sc1
    s_mov_b64 exec, -1
L_pc_20:
    v_mov_b32 v76, 0
    s_mov_b32 exec_lo, 16777215
    s_mov_b32 exec_hi, 16777215
    s_waitcnt vmcnt(7)
    v_xor_b32 v104, v30, v104
    v_xor_b32 v105, v30, v105
    v_xor_b32 v106, v30, v106
    v_xor_b32 v107, v30, v107
    v_or_b32 v76, v104, v105
    v_or3_b32 v76, v76, v106, v107
    s_waitcnt vmcnt(6)
    v_xor_b32 v108, v30, v108
    v_xor_b32 v109, v30, v109
    v_xor_b32 v110, v30, v110
    v_xor_b32 v111, v30, v111
    v_or3_b32 v76, v76, v108, v109
    v_or3_b32 v76, v76, v110, v111
    v_pk_add_f32 v[40:41], v[104:105], v[108:109]
    v_pk_add_f32 v[42:43], v[106:107], v[110:111]
    s_waitcnt vmcnt(5)
    v_xor_b32 v112, v30, v112
    v_xor_b32 v113, v30, v113
    v_xor_b32 v114, v30, v114
    v_xor_b32 v115, v30, v115
    v_or3_b32 v76, v76, v112, v113
    v_or3_b32 v76, v76, v114, v115
    v_pk_add_f32 v[40:41], v[40:41], v[112:113]
    v_pk_add_f32 v[42:43], v[42:43], v[114:115]
    s_waitcnt vmcnt(4)
    v_xor_b32 v116, v30, v116
    v_xor_b32 v117, v30, v117
    v_xor_b32 v118, v30, v118
    v_xor_b32 v119, v30, v119
    v_or3_b32 v76, v76, v116, v117
    v_or3_b32 v76, v76, v118, v119
    v_pk_add_f32 v[40:41], v[40:41], v[116:117]
    v_pk_add_f32 v[42:43], v[42:43], v[118:119]
    s_waitcnt vmcnt(3)
    v_xor_b32 v120, v30, v120
    v_xor_b32 v121, v30, v121
    v_xor_b32 v122, v30, v122
    v_xor_b32 v123, v30, v123
    v_or3_b32 v76, v76, v120, v121
    v_or3_b32 v76, v76, v122, v123
    v_pk_add_f32 v[40:41], v[40:41], v[120:121]
    v_pk_add_f32 v[42:43], v[42:43], v[122:123]
    s_waitcnt vmcnt(2)
    v_xor_b32 v124, v30, v124
    v_xor_b32 v125, v30, v125
    v_xor_b32 v126, v30, v126
    v_xor_b32 v127, v30, v127
    v_or3_b32 v76, v76, v124, v125
    v_or3_b32 v76, v76, v126, v127
    v_pk_add_f32 v[40:41], v[40:41], v[124:125]
    v_pk_add_f32 v[42:43], v[42:43], v[126:127]
    s_waitcnt vmcnt(1)
    v_xor_b32 v128, v30, v128
    v_xor_b32 v129, v30, v129
    v_xor_b32 v130, v30, v130
    v_xor_b32 v131, v30, v131
    v_or3_b32 v76, v76, v128, v129
    v_or3_b32 v76, v76, v130, v131
    v_pk_add_f32 v[40:41], v[40:41], v[128:129]
    v_pk_add_f32 v[42:43], v[42:43], v[130:131]
    s_waitcnt vmcnt(0)
    v_xor_b32 v132, v30, v132
    v_xor_b32 v133, v30, v133
    v_xor_b32 v134, v30, v134
    v_xor_b32 v135, v30, v135
    v_or3_b32 v76, v76, v132, v133
    v_or3_b32 v76, v76, v134, v135
    v_pk_add_f32 v[40:41], v[40:41], v[132:133]
    v_pk_add_f32 v[42:43], v[42:43], v[134:135]
    s_mov_b64 exec, -1
    v_and_b32 v76, s77, v76
    v_cmp_ne_u32 vcc, 0, v76
    s_cbranch_vccz L_pd_21
    s_add_u32 s79, s79, 1
    s_cmp_lt_u32 s79, 4000000
    s_cbranch_scc1 L_pr_22
L_pd_21:
    ds_write_b128 v16, v[40:43]
    s_waitcnt lgkmcnt(0)
    s_barrier
    ds_read_b128 v[40:43], v19 offset:0
    ds_read_b128 v[44:47], v19 offset:1024
    ds_read_b128 v[48:51], v19 offset:2048
    ds_read_b128 v[52:55], v19 offset:3072
    s_waitcnt lgkmcnt(2)
    v_pk_add_f32 v[40:41], v[40:41], v[44:45]
    v_pk_add_f32 v[42:43], v[42:43], v[46:47]
    s_waitcnt lgkmcnt(0)
    v_pk_add_f32 v[48:49], v[48:49], v[52:53]
    v_pk_add_f32 v[50:51], v[50:51], v[54:55]
    v_pk_add_f32 v[40:41], v[40:41], v[48:49]
    v_pk_add_f32 v[42:43], v[42:43], v[50:51]
    v_cvt_pk_bf16_f32 v44, v40, v41
    v_cvt_pk_bf16_f32 v45, v42, v43
    v_lshlrev_b32 v40, 16, v44
    v_and_b32 v41, 0xffff0000, v44
    v_lshlrev_b32 v42, 16, v45
    v_and_b32 v43, 0xffff0000, v45
    v_pk_add_f32 v[40:41], v[40:41], v[100:101]
    v_pk_add_f32 v[42:43], v[42:43], v[102:103]
    v_cvt_pk_bf16_f32 v48, v40, v40
    v_cvt_pk_bf16_f32 v49, v41, v41
    v_cvt_pk_bf16_f32 v50, v42, v42
    v_cvt_pk_bf16_f32 v51, v43, v43
    s_mov_b32 exec_lo, 0xffffff
    s_mov_b32 exec_hi, 0xffffff
    ds_write_b128 v17, v[48:51]
    s_mov_b64 exec, -1
    s_waitcnt lgkmcnt(0)
    ds_read_b64 v[96:97], v24 offset:0
    ds_read_b64 v[98:99], v24 offset:64
    ds_read_b64 v[100:101], v24 offset:128
    v_and_b32 v60, 0xffff0000, v48
    v_and_b32 v61, 0xffff0000, v49
    v_and_b32 v62, 0xffff0000, v50
    v_and_b32 v63, 0xffff0000, v51
    s_waitcnt lgkmcnt(2)
    v_and_b32 v84, v96, v36
    v_and_b32 v85, v96, v37
    v_and_b32 v86, v97, v36
    v_and_b32 v87, v97, v37
    s_waitcnt lgkmcnt(1)
    v_and_b32 v88, v98, v36
    v_and_b32 v89, v98, v37
    v_and_b32 v90, v99, v36
    v_and_b32 v91, v99, v37
    s_waitcnt lgkmcnt(0)
    v_and_b32 v92, v100, v36
    v_and_b32 v93, v100, v37
    v_and_b32 v94, v101, v36
    v_and_b32 v95, v101, v37
    v_mfma_f32_16x16x32_bf16 v[240:243], v[84:87], v[168:171], 0
    v_sub_f32 v44, v60, v29
    v_sub_f32 v45, v61, v29
    v_mfma_f32_16x16x32_bf16 v[240:243], v[88:91], v[192:195], v[240:243]
    v_sub_f32 v46, v62, v29
    v_sub_f32 v47, v63, v29
    v_mfma_f32_16x16x32_bf16 v[240:243], v[92:95], v[216:219], v[240:243]
    v_add_f32 v52, v44, v45
    v_add_f32 v53, v46, v47
    v_mfma_f32_16x16x32_bf16 v[244:247], v[84:87], v[172:175], 0
    v_mul_f32 v54, v44, v44
    v_mul_f32 v55, v45, v45
    v_mfma_f32_16x16x32_bf16 v[244:247], v[88:91], v[196:199], v[244:247]
    v_fmac_f32 v54, v46, v46
    v_fmac_f32 v55, v47, v47
    v_mfma_f32_16x16x32_bf16 v[244:247], v[92:95], v[220:223], v[244:247]
    v_add_f32 v52, v52, v53
    v_add_f32 v53, v54, v55
    v_mfma_f32_16x16x32_bf16 v[248:251], v[84:87], v[176:179], 0
    v_cmp_gt_u32 vcc, 24, v5
    s_nop 0
    v_mfma_f32_16x16x32_bf16 v[248:251], v[88:91], v[200:203], v[248:251]
    v_cndmask_b32 v52, 0, v52, vcc
    v_cndmask_b32 v53, 0, v53, vcc
    v_mfma_f32_16x16x32_bf16 v[248:251], v[92:95], v[224:227], v[248:251]
    v_add_f32_dpp v52, v52, v52 row_ror:8 row_mask:0xf bank_mask:0xf
    v_add_f32_dpp v53, v53, v53 row_ror:8 row_mask:0xf bank_mask:0xf
    ds_write_b128 v22, v[240:243] offset:0
    v_mfma_f32_16x16x32_bf16 v[252:255], v[84:87], v[180:183], 0
    v_add_f32_dpp v52, v52, v52 row_ror:4 row_mask:0xf bank_mask:0xf
    v_add_f32_dpp v53, v53, v53 row_ror:4 row_mask:0xf bank_mask:0xf
    v_mfma_f32_16x16x32_bf16 v[252:255], v[88:91], v[204:207], v[252:255]
    v_add_f32_dpp v52, v52, v52 row_ror:2 row_mask:0xf bank_mask:0xf
    v_add_f32_dpp v53, v53, v53 row_ror:2 row_mask:0xf bank_mask:0xf
    v_mfma_f32_16x16x32_bf16 v[252:255], v[92:95], v[228:231], v[252:255]
    v_add_f32_dpp v52, v52, v52 row_ror:1 row_mask:0xf bank_mask:0xf
    v_add_f32_dpp v53, v53, v53 row_ror:1 row_mask:0xf bank_mask:0xf
    ds_write_b128 v22, v[244:247] offset:16
    v_mfma_f32_16x16x32_bf16 v[76:79], v[84:87], v[184:187], 0
    v_mov_b32 v54, v52
    v_mov_b32 v55, v53
    v_mfma_f32_16x16x32_bf16 v[76:79], v[88:91], v[208:211], v[76:79]
    v_permlane16_swap_b32 v52, v54
    v_permlane16_swap_b32 v53, v55
    v_mfma_f32_16x16x32_bf16 v[76:79], v[92:95], v[232:235], v[76:79]
    v_add_f32 v52, v52, v54
    v_add_f32 v53, v53, v55
    ds_write_b128 v22, v[248:251] offset:256
    v_mfma_f32_16x16x32_bf16 v[80:83], v[84:87], v[188:191], 0
    v_mov_b32 v54, v52
    v_mov_b32 v55, v53
    v_mfma_f32_16x16x32_bf16 v[80:83], v[88:91], v[212:215], v[80:83]
    v_permlane32_swap_b32 v52, v54
    v_permlane32_swap_b32 v53, v55
    v_mfma_f32_16x16x32_bf16 v[80:83], v[92:95], v[236:239], v[80:83]
    v_bfi_b32 v52, s77, v30, v52
    v_bfi_b32 v53, s77, v30, v53
    ds_write_b128 v22, v[252:255] offset:272
    v_bfi_b32 v54, s77, v30, v54
    v_bfi_b32 v55, s77, v30, v55
    ds_write_b128 v22, v[76:79] offset:512
    s_nop 1
    ds_write_b128 v22, v[80:83] offset:528
    s_cmp_lg_u32 s3, 3
    s_cbranch_scc1 L_nost
    s_mov_b64 exec, 0xff
    buffer_store_dwordx4 v[52:55], v39, s[64:67], s86 offen
    s_cmp_lg_u32 s61, 0
    s_cbranch_scc1 L_pub_23
    buffer_store_dwordx4 v[52:55], v39, s[64:67], s86 offen sc1
L_pub_23:
    s_mov_b64 exec, -1
L_nost:
    s_waitcnt lgkmcnt(0)
    s_barrier
    s_mov_b32 exec_lo, -1
    s_mov_b32 exec_hi, 0xffff
    ds_read_b128 v[104:107], v23 offset:0
    ds_read_b128 v[108:111], v23 offset:1536
    ds_read_b128 v[112:115], v23 offset:3072
    ds_read_b128 v[116:119], v23 offset:4608
    s_waitcnt lgkmcnt(2)
    v_pk_add_f32 v[104:105], v[104:105], v[108:109]
    v_pk_add_f32 v[106:107], v[106:107], v[110:111]
    s_waitcnt lgkmcnt(0)
    v_pk_add_f32 v[112:113], v[112:113], v[116:117]
    v_pk_add_f32 v[114:115], v[114:115], v[118:119]
    v_pk_add_f32 v[104:105], v[104:105], v[112:113]
    v_pk_add_f32 v[106:107], v[106:107], v[114:115]
    v_bfi_b32 v104, s77, v30, v104
    v_bfi_b32 v105, s77, v30, v105
    v_bfi_b32 v106, s77, v30, v106
    v_bfi_b32 v107, s77, v30, v107
    buffer_store_dwordx4 v[104:107], v39, s[64:67], s85 offen
    s_cmp_lg_u32 s61, 0
    s_cbranch_scc1 L_pub_24
    buffer_store_dwordx4 v[104:107], v39, s[64:67], s85 offen sc1
L_pub_24:
    s_mov_b64 exec, -1
    s_cmp_lg_u32 s3, 0
    s_cbranch_scc1 L_fin
    s_mov_b32 exec_lo, 0xffffff
    s_mov_b32 exec_hi, 0xffffff
    ds_write_b128 v25, v[60:63]
    s_mov_b64 exec, -1
    s_waitcnt lgkmcnt(0)
    ds_read_b32 v64, v8
    buffer_load_dword v48, v7, s[64:67], s40 offen sc1
    buffer_load_dword v49, v7, s[64:67], s41 offen sc1
    buffer_load_dword v50, v7, s[64:67], s42 offen sc1
    s_waitcnt vmcnt(0)
    s_branch L_gc_25
L_gr_27:
    buffer_load_dword v48, v7, s[64:67], s40 offen sc1
    buffer_load_dword v49, v7, s[64:67], s41 offen sc1
    buffer_load_dword v50, v7, s[64:67], s42 offen sc1
    s_waitcnt vmcnt(0)
L_gc_25:
    v_xor_b32 v48, v30, v48
    v_xor_b32 v49, v30, v49
    v_xor_b32 v50, v30, v50
    v_or_b32 v76, v48, v49
    v_or_b32 v76, v76, v50
    v_and_b32 v76, s77, v76
    v_cmp_ne_u32 vcc, 0, v76
    s_cbranch_vccz L_gd_26
    s_add_u32 s79, s79, 1
    s_cmp_lt_u32 s79, 4000000
    s_cbranch_scc1 L_gr_27
L_gd_26:
    v_add_f32 v40, v48, v49
    v_add_f32 v40, v40, v50
    s_nop 1
    v_add_f32_dpp v40, v40, v40 row_ror:8 row_mask:0xf bank_mask:0xf
    v_mov_b32 v41, v40
    s_nop 1
    v_permlane16_swap_b32 v40, v41
    v_add_f32 v40, v40, v41
    v_mov_b32 v41, v40
    s_nop 1
    v_permlane32_swap_b32 v40, v41
    v_add_f32 v40, v40, v41
    v_cvt_pk_bf16_f32 v40, v40, v40
    v_and_b32 v40, 0xffff0000, v40
    s_waitcnt lgkmcnt(0)
    v_add_f32 v40, v40, v64
    v_cvt_pk_bf16_f32 v40, v40, v40
    s_mov_b64 exec, 0xff
    buffer_store_short v40, v3, s[72:75], s43 offen
    s_cmp_lg_u32 s2, 0
    s_cbranch_scc1 L_fin
    s_mov_b64 exec, 1
    v_mov_b32 v41, s78
    v_mov_b32 v42, 0
    buffer_store_dword v41, v42, s[64:67], 0 offen sc1
L_fin:
L_end:
    s_endpgm

.section .rodata,"a"
.p2align 6
.amdhsa_kernel sequential_preLN__sliding_block_cached__glu_gated_swiglu__decode_kernel
  .amdhsa_next_free_vgpr 256
  .amdhsa_next_free_sgpr 102
  .amdhsa_accum_offset 256
  .amdhsa_group_segment_fixed_size 0
  .amdhsa_kernarg_size 96
  .amdhsa_user_sgpr_count 2
  .amdhsa_user_sgpr_kernarg_segment_ptr 1
  .amdhsa_system_sgpr_workgroup_id_x 1
.end_amdhsa_kernel
```
